```python
import torch

def _softmax(x, axis=-1):
    return torch.softmax(x, dim=axis)
def _gelu(x):
    return torch.nn.functional.gelu(x, approximate="tanh")
def _silu(x):
    return torch.nn.functional.silu(x)
def _sigmoid(x):
    return torch.sigmoid(x)
def _layernorm(x, axis=-1, eps=1e-5):
    m = x.mean(dim=axis, keepdim=True)
    v = x.var(dim=axis, keepdim=True, unbiased=False)
    return (x - m) / torch.sqrt(v + eps)
def _scatter_add(tgt, idx, src, axis=0):
    return tgt.clone().index_add_(axis, idx, src)
def _segment_sum(src, seg, n):
    out = torch.zeros((n,) + src.shape[1:], dtype=src.dtype)
    return out.index_add_(0, seg, src)
def _pad(x, pw):
    flat = tuple(v for pair in reversed(pw) for v in pair)
    return torch.nn.functional.pad(x, flat)

kernel_name = 'concat_heads__sliding_block_cached__sliding_block_cached__decode'

def setup_inputs():

    _w = (lambda a: (lambda t: t.to(torch.bfloat16) if t.is_floating_point() else t)(torch.as_tensor(a)))
    def _A_setup():
        B, Sq, D = 8, 1, 1024
        Hq, Hkv, Sk, Dh = 32, 4, 4096, 128
        assert Hq % Hkv == 0, (Hq, Hkv)
        return {
            "x": _w((lambda *s: torch.randn(*s, dtype=torch.bfloat16) * 0.8)(B, Sq, D)),
            "k_cache": _w((lambda *s: torch.randn(*s, dtype=torch.bfloat16) * 0.8)(B, Hkv, Sk, Dh)),
            "v_cache": _w((lambda *s: torch.randn(*s, dtype=torch.bfloat16) * 0.05)(B, Hkv, Sk, Dh)),
            "wq": _w((lambda *s: torch.randn(*s, dtype=torch.bfloat16) * 0.8)(D, Hq * Dh) * (D ** -0.5)),
            "wo": _w((lambda *s: torch.randn(*s, dtype=torch.bfloat16) * 0.05)(Hq * Dh, D) * ((Hq * Dh) ** -0.5)),
        }
    _A_in = _A_setup()

    def _B_setup():
        B, Sq, D = 8, 1, 1024
        Hq, Hkv, Sk, Dh = 32, 4, 4096, 128
        assert Hq % Hkv == 0, (Hq, Hkv)
        return {
            "x": _w((lambda *s: torch.randn(*s, dtype=torch.bfloat16) * 0.8)(B, Sq, D)),
            "k_cache": _w((lambda *s: torch.randn(*s, dtype=torch.bfloat16) * 0.8)(B, Hkv, Sk, Dh)),
            "v_cache": _w((lambda *s: torch.randn(*s, dtype=torch.bfloat16) * 0.05)(B, Hkv, Sk, Dh)),
            "wq": _w((lambda *s: torch.randn(*s, dtype=torch.bfloat16) * 0.8)(D, Hq * Dh) * (D ** -0.5)),
            "wo": _w((lambda *s: torch.randn(*s, dtype=torch.bfloat16) * 0.05)(Hq * Dh, D) * ((Hq * Dh) ** -0.5)),
        }
    _B_in = _B_setup()

    return {
        "A_x": _A_in["x"],
        "A_k_cache": _A_in["k_cache"],
        "A_v_cache": _A_in["v_cache"],
        "A_wq": _A_in["wq"],
        "A_wo": _A_in["wo"],
        "B_x": _B_in["x"],
        "B_k_cache": _B_in["k_cache"],
        "B_v_cache": _B_in["v_cache"],
        "B_wq": _B_in["wq"],
        "B_wo": _B_in["wo"],
    }

def reference(A_x, A_k_cache, A_v_cache, A_wq, A_wo, B_x, B_k_cache, B_v_cache, B_wq, B_wo):
    def _A_ref(x, k_cache, v_cache, wq, wo):
        B, Sq, D = x.shape
        Hq, Dh = 32, 128
        Hkv, Sk = k_cache.shape[1], k_cache.shape[2]
        W = min(4096, max(256, Sk // 4))
        rep = Hq // Hkv
        q = (lambda x, *d: x.permute(*d))((x @ wq).reshape(B, Sq, Hq, Dh), 0, 2, 1, 3)
        k = (lambda x, n, axis: torch.repeat_interleave(x, n, dim=axis))(k_cache[:, :, Sk - W:, :], rep, axis=1)
        v = (lambda x, n, axis: torch.repeat_interleave(x, n, dim=axis))(v_cache[:, :, Sk - W:, :], rep, axis=1)
        scores = torch.einsum("bhqd,bhkd->bhqk", q, k) * (Dh ** -0.5)
        p = _softmax(scores, axis=-1)
        o = torch.einsum("bhqk,bhkd->bhqd", p, v)
        return (lambda x, *d: x.permute(*d))(o, 0, 2, 1, 3).reshape(B, Sq, Hq * Dh) @ wo

    def _B_ref(x, k_cache, v_cache, wq, wo):
        B, Sq, D = x.shape
        Hq, Dh = 32, 128
        Hkv, Sk = k_cache.shape[1], k_cache.shape[2]
        W = min(4096, max(256, Sk // 4))
        rep = Hq // Hkv
        q = (lambda x, *d: x.permute(*d))((x @ wq).reshape(B, Sq, Hq, Dh), 0, 2, 1, 3)
        k = (lambda x, n, axis: torch.repeat_interleave(x, n, dim=axis))(k_cache[:, :, Sk - W:, :], rep, axis=1)
        v = (lambda x, n, axis: torch.repeat_interleave(x, n, dim=axis))(v_cache[:, :, Sk - W:, :], rep, axis=1)
        scores = torch.einsum("bhqd,bhkd->bhqk", q, k) * (Dh ** -0.5)
        p = _softmax(scores, axis=-1)
        o = torch.einsum("bhqk,bhkd->bhqd", p, v)
        return (lambda x, *d: x.permute(*d))(o, 0, 2, 1, 3).reshape(B, Sq, Hq * Dh) @ wo

    a = _A_ref(A_x, A_k_cache, A_v_cache, A_wq, A_wo)
    b = _B_ref(B_x, B_k_cache, B_v_cache, B_wq, B_wo)
    return torch.concatenate([a, b], axis=-1)
```

```asm
; @launch grid=(256,1,1) block=(576,1,1) lds=142336
.amdgcn_target "amdgcn-amd-amdhsa--gfx950"
.text
.p2align 10
.fill 64, 4, 0xbf800000
.globl concat_heads__sliding_block_cached__sliding_block_cached__decode_kernel
.p2align 8
.type concat_heads__sliding_block_cached__sliding_block_cached__decode_kernel,@function
concat_heads__sliding_block_cached__sliding_block_cached__decode_kernel:
    s_cmp_ge_u32 s2, 256
    s_cbranch_scc1 L_end
    s_bfe_u32 s5, s2, 0x10002
    s_mul_i32 s7, s5, 40
    s_add_u32 s8, s0, s7
    s_addc_u32 s9, s1, 0
    s_load_dwordx2 s[44:45], s[8:9], 24
    s_load_dwordx2 s[20:21], s[0:1], 96
    v_lshrrev_b32 v1, 6, v0
    v_and_b32 v2, 63, v0
    v_readfirstlane_b32 s22, v1
    s_and_b32 s3, s2, 7
    s_lshr_b32 s4, s2, 3
    s_and_b32 s6, s2, 3
    s_and_b32 s34, s4, 3
    s_lshr_b32 s35, s4, 2
    s_mov_b32 s33, 0x2000000
    v_lshrrev_b32 v4, 4, v2
    v_and_b32 v5, 15, v2
    s_mul_i32 s66, s34, 4
    s_and_b32 s66, s66, 62
    s_mul_i32 s68, s35, 8
    s_and_b32 s68, s68, 62
    s_cmp_eq_u32 s22, 0
    s_cbranch_scc1 L_loader
    s_load_dwordx2 s[40:41], s[8:9], 0
    s_barrier
    s_branch L_compute
L_loader:
    s_setprio 3
    s_load_dwordx4 s[12:15], s[8:9], 8
    s_load_dwordx2 s[56:57], s[8:9], 32
    s_load_dwordx2 s[40:41], s[0:1], 80
    v_lshlrev_b32 v8, 3, v2
    v_add_u32 v8, 141824, v8
    v_mov_b32 v10, 0
    v_mov_b32 v11, 0
    ds_write_b64 v8, v[10:11]
    v_lshrrev_b32 v6, 1, v5
    v_xor_b32 v6, v6, v4
    v_lshlrev_b32 v6, 5, v6
    v_and_b32 v7, 1, v2
    v_lshl_add_u32 v6, v7, 4, v6
    v_lshl_add_u32 v64, v4, 13, v6
    s_and_b32 s7, s66, 35
    s_lshl_b32 s7, s7, 15
    v_xor_b32 v64, s7, v64
    v_xor_b32 v65, 32768, v64
    v_xor_b32 v66, 65664, v64
    v_xor_b32 v67, 98432, v64
    v_xor_b32 v68, 1048576, v64
    v_xor_b32 v69, 1081344, v64
    v_xor_b32 v70, 1114240, v64
    v_xor_b32 v71, 1147008, v64
    s_lshl_b32 s60, s34, 21
    s_lshl_b32 s7, s6, 11
    s_add_u32 s60, s60, s7
    s_lshl_b32 s7, s35, 8
    s_add_u32 s60, s60, s7
    s_and_b32 s64, s66, 28
    s_lshl_b32 s64, s64, 15
    s_mov_b32 s46, 8388608
    s_mov_b32 s47, 0x20000
    s_mov_b32 m0, 0
    v_lshlrev_b32 v8, 2, v2
    v_add_u32 v8, 142080, v8
    s_movk_i32 s30, 1024
    s_mov_b32 s31, 0
    s_mov_b32 s50, 0
    s_mov_b32 s32, 1
    s_lshl_b32 s7, s5, 7
    s_waitcnt lgkmcnt(0)
    s_load_dword s24, s[20:21], s7
L_pre:
    s_xor_b32 s7, s31, s64
    s_add_u32 s29, s7, s60
    buffer_load_dwordx4 v64, s[44:47], s29 offen nt lds
    s_add_u32 m0, m0, s30
    s_nop 0
    buffer_load_dwordx4 v65, s[44:47], s29 offen nt lds
    s_add_u32 m0, m0, s30
    s_nop 0
    buffer_load_dwordx4 v66, s[44:47], s29 offen nt lds
    s_add_u32 m0, m0, s30
    s_nop 0
    buffer_load_dwordx4 v67, s[44:47], s29 offen nt lds
    s_add_u32 m0, m0, s30
    s_nop 0
    buffer_load_dwordx4 v68, s[44:47], s29 offen nt lds
    s_add_u32 m0, m0, s30
    s_nop 0
    buffer_load_dwordx4 v69, s[44:47], s29 offen nt lds
    s_add_u32 m0, m0, s30
    s_nop 0
    buffer_load_dwordx4 v70, s[44:47], s29 offen nt lds
    s_add_u32 m0, m0, s30
    s_nop 0
    buffer_load_dwordx4 v71, s[44:47], s29 offen nt lds
    s_add_u32 m0, m0, s30
    s_add_u32 s31, s31, 131072
    s_cmp_lt_u32 s31, 393216
    s_cbranch_scc1 L_pre
    s_barrier
    s_mov_b32 s36, s20
    s_mov_b32 s37, s21
    s_mov_b32 s38, 4194304
    s_mov_b32 s39, 0x20000
    v_lshlrev_b32 v12, 13, v4
    v_lshl_add_u32 v12, v5, 4, v12
    s_lshl_b32 s10, s3, 16
    s_lshl_b32 s7, s4, 8
    s_add_u32 s10, s10, s7
    s_add_u32 s10, s10, 2097152
    s_add_u32 s11, s10, 32768
    v_mov_b32 v28, -1
    v_mov_b32 v29, -1
    v_mov_b32 v30, -1
    v_mov_b32 v31, -1
    buffer_store_dwordx4 v[28:31], v12, s[36:39], s10 offen sc1
    buffer_store_dwordx4 v[28:31], v12, s[36:39], s11 offen sc1
    v_mov_b32 v10, 141824
    s_mul_i32 s67, s4, 1
    s_and_b32 s67, s67, 63
    s_and_b32 s7, s67, 35
    s_lshl_b32 s7, s7, 10
    v_xor_b32 v72, v5, v4
    v_lshlrev_b32 v72, 4, v72
    v_lshl_add_u32 v72, v4, 8, v72
    v_xor_b32 v72, s7, v72
    v_xor_b32 v73, 1088, v72
    v_xor_b32 v74, 2176, v72
    v_xor_b32 v75, 3264, v72
    v_xor_b32 v76, 32768, v72
    v_xor_b32 v77, 33856, v72
    v_xor_b32 v78, 34944, v72
    v_xor_b32 v79, 36032, v72
    v_lshl_add_u32 v80, v4, 8, v6
    v_xor_b32 v80, s7, v80
    v_xor_b32 v81, 1152, v80
    v_xor_b32 v82, 2048, v80
    v_xor_b32 v83, 3200, v80
    v_xor_b32 v84, 32768, v80
    v_xor_b32 v85, 33920, v80
    v_xor_b32 v86, 34816, v80
    v_xor_b32 v87, 35968, v80
    v_lshl_add_u32 v88, v4, 11, v6
    s_and_b32 s7, s68, 7
    s_lshl_b32 s7, s7, 13
    v_xor_b32 v88, s7, v88
    v_xor_b32 v89, 8192, v88
    v_xor_b32 v90, 16512, v88
    v_xor_b32 v91, 24704, v88
    v_xor_b32 v92, 32768, v88
    v_xor_b32 v93, 40960, v88
    v_xor_b32 v94, 49280, v88
    v_xor_b32 v95, 57472, v88
    s_lshl_b32 s61, s35, 22
    s_lshl_b32 s7, s6, 20
    s_add_u32 s61, s61, s7
    s_lshl_b32 s7, s34, 16
    s_add_u32 s61, s61, s7
    s_add_u32 s61, s61, 786432
    s_and_b32 s65, s67, 28
    s_lshl_b32 s65, s65, 10
    s_lshr_b32 s62, s4, 1
    s_and_b32 s49, s4, 1
    s_lshl_b32 s63, s62, 19
    s_lshl_b32 s7, s6, 9
    s_add_u32 s63, s63, s7
    s_lshl_b32 s7, s49, 8
    s_add_u32 s63, s63, s7
    s_and_b32 s69, s68, 56
    s_lshl_b32 s69, s69, 13
    s_mov_b32 s52, s12
    s_mov_b32 s53, s13
    s_mov_b32 s54, 33554432
    s_mov_b32 s55, 0x20000
    s_mov_b32 s12, s14
    s_mov_b32 s13, s15
    s_mov_b32 s14, 33554432
    s_mov_b32 s15, 0x20000
    s_mov_b32 s58, 8388608
    s_mov_b32 s59, 0x20000
    s_mov_b32 s36, s20
    s_mov_b32 s37, s21
    s_mov_b32 s38, 4194304
    s_mov_b32 s39, 0x20000
    s_mov_b32 s42, 32768
    s_mov_b32 s43, 0x20000
    v_lshlrev_b32 v24, 13, v4
    v_lshl_add_u32 v24, v5, 4, v24
    v_add_u32 v25, 32768, v24
    v_add_u32 v26, 65536, v24
    v_add_u32 v27, 98304, v24
    s_lshl_b32 s18, s3, 17
    s_lshl_b32 s7, s49, 12
    s_add_u32 s18, s18, s7
    s_lshl_b32 s7, s62, 8
    s_add_u32 s18, s18, s7
    s_add_u32 s18, s18, 1048576
    s_lshl_b32 s19, s3, 9
    s_lshl_b32 s7, s49, 8
    s_add_u32 s19, s19, s7
    s_lshr_b32 s7, s62, 2
    s_lshl_b32 s7, s7, 6
    s_add_u32 s19, s19, s7
    s_and_b32 s7, s62, 3
    s_lshl_b32 s7, s7, 3
    s_add_u32 s19, s19, s7
    v_and_b32 v14, 7, v2
    v_lshlrev_b32 v14, 12, v14
    v_bfe_u32 v12, v2, 3, 1
    v_lshl_add_u32 v14, v12, 5, v14
    v_lshl_add_u32 v14, v4, 1, v14
    s_lshl_b32 s23, s3, 12
    s_lshl_b32 s7, s35, 9
    s_add_u32 s23, s23, s7
    s_add_u32 s23, s23, 327680
    s_getreg_b32 s10, hwreg(HW_REG_XCC_ID, 0, 3)
    s_lshl_b32 s11, s3, 9
    s_lshr_b32 s7, s4, 3
    s_lshl_b32 s7, s7, 7
    s_add_u32 s11, s11, s7
    s_and_b32 s7, s4, 7
    s_lshl_b32 s7, s7, 2
    s_add_u32 s11, s11, s7
    s_add_u32 s11, s11, 196608
    s_waitcnt lgkmcnt(0)
    s_add_u32 s24, s24, 0x01010101
    s_mov_b32 s25, s24
    s_lshr_b32 s26, s24, 8
    s_lshr_b32 s27, s24, 16
    s_lshr_b32 s28, s24, 24
    v_mov_b32 v21, s24
    s_and_b32 s16, s24, 255
    s_mul_i32 s16, s16, 0x01010101
    s_mov_b32 s17, s16
    s_xor_b32 s25, s25, 0x80
    s_xor_b32 s26, s26, 0x80
    s_xor_b32 s27, s27, 0x80
    s_xor_b32 s28, s28, 0x80
    s_and_b32 s7, s24, -8
    s_or_b32 s7, s7, s10
    v_mov_b32 v13, s7
    v_mov_b32 v12, 0
    s_mov_b64 exec, 1
    buffer_store_dword v13, v12, s[36:39], s11 offen sc1
    s_mov_b64 exec, -1
    s_xor_b32 s29, s31, s64
    s_add_u32 s29, s29, s60
    s_nop 0
L_ph0:
    s_waitcnt vmcnt(23)
    buffer_load_dwordx4 v64, s[44:47], s29 offen nt lds
    s_add_u32 m0, m0, s30
    s_waitcnt vmcnt(23)
    buffer_load_dwordx4 v65, s[44:47], s29 offen nt lds
    s_add_u32 m0, m0, s30
    s_waitcnt vmcnt(23)
    buffer_load_dwordx4 v66, s[44:47], s29 offen nt lds
    s_add_u32 m0, m0, s30
    s_waitcnt vmcnt(23)
    buffer_load_dwordx4 v67, s[44:47], s29 offen nt lds
    s_add_u32 m0, m0, s30
    s_waitcnt vmcnt(23)
    buffer_load_dwordx4 v68, s[44:47], s29 offen nt lds
    s_add_u32 m0, m0, s30
    s_waitcnt vmcnt(23)
    buffer_load_dwordx4 v69, s[44:47], s29 offen nt lds
    s_add_u32 m0, m0, s30
    s_waitcnt vmcnt(23)
    buffer_load_dwordx4 v70, s[44:47], s29 offen nt lds
    s_add_u32 m0, m0, s30
    s_waitcnt vmcnt(23)
    buffer_load_dwordx4 v71, s[44:47], s29 offen nt lds
    s_add_u32 m0, m0, s30
    s_max_i32 s50, s50, s32
    v_mov_b32 v9, s50
    ds_write_b32 v8, v9
    s_add_i32 s32, s32, 1
    s_nop 0
    s_add_u32 s31, s31, 131072
    s_xor_b32 s29, s31, s64
    s_add_u32 s29, s29, s60
    s_cmp_lt_u32 s31, 1048576
    s_cbranch_scc1 L_ph0
    s_mov_b32 m0, 65536
    s_mov_b32 s31, 0
    s_xor_b32 s29, s31, s65
    s_add_u32 s29, s29, s61
    s_nop 0
L_ph1:
    s_waitcnt vmcnt(23)
    buffer_load_dwordx4 v72, s[52:55], s29 offen nt lds
    s_add_u32 m0, m0, s30
    s_waitcnt vmcnt(23)
    buffer_load_dwordx4 v73, s[52:55], s29 offen nt lds
    s_add_u32 m0, m0, s30
    s_waitcnt vmcnt(23)
    buffer_load_dwordx4 v74, s[52:55], s29 offen nt lds
    s_add_u32 m0, m0, s30
    s_waitcnt vmcnt(23)
    buffer_load_dwordx4 v75, s[52:55], s29 offen nt lds
    s_add_u32 m0, m0, s30
    s_waitcnt vmcnt(23)
    buffer_load_dwordx4 v76, s[52:55], s29 offen nt lds
    s_add_u32 m0, m0, s30
    s_waitcnt vmcnt(23)
    buffer_load_dwordx4 v77, s[52:55], s29 offen nt lds
    s_add_u32 m0, m0, s30
    s_waitcnt vmcnt(23)
    buffer_load_dwordx4 v78, s[52:55], s29 offen nt lds
    s_add_u32 m0, m0, s30
    s_waitcnt vmcnt(23)
    buffer_load_dwordx4 v79, s[52:55], s29 offen nt lds
    s_add_u32 m0, m0, s30
    s_max_i32 s50, s50, s32
    v_mov_b32 v9, s50
    ds_write_b32 v8, v9
    ds_read_b128 v[16:19], v10
    s_add_i32 s32, s32, 1
    s_nop 0
    s_add_u32 s31, s31, 4096
    s_xor_b32 s29, s31, s65
    s_add_u32 s29, s29, s61
    s_cmp_lt_u32 s31, 32768
    s_cbranch_scc1 L_ph1
    s_add_i32 s32, s32, -1
    s_mov_b32 m0, 0
    s_mov_b32 s31, 0
    s_waitcnt lgkmcnt(0)
F_1:
    v_readfirstlane_b32 s7, v17
    s_cmp_ge_u32 s7, 4
    s_cbranch_scc1 FE_2
    ds_read_b128 v[16:19], v10
    s_waitcnt lgkmcnt(0)
    s_sub_u32 s33, s33, 1
    s_cbranch_scc0 F_1
    s_mov_b32 s33, 0
FE_2:
    s_xor_b32 s29, s31, s65
    s_add_u32 s29, s29, s61
    s_nop 0
L_ph2:
    s_waitcnt vmcnt(25)
    buffer_load_dwordx4 v80, s[12:15], s29 offen nt lds
    s_add_u32 m0, m0, s30
    s_waitcnt vmcnt(25)
    buffer_load_dwordx4 v81, s[12:15], s29 offen nt lds
    s_add_u32 m0, m0, s30
    s_max_i32 s50, s50, s32
    v_mov_b32 v9, s50
    ds_write_b32 v8, v9
    ds_read_b128 v[16:19], v10
    s_add_i32 s32, s32, 1
    s_nop 0
    s_waitcnt vmcnt(25)
    buffer_load_dwordx4 v82, s[12:15], s29 offen nt lds
    s_add_u32 m0, m0, s30
    s_waitcnt vmcnt(25)
    buffer_load_dwordx4 v83, s[12:15], s29 offen nt lds
    s_add_u32 m0, m0, s30
    s_waitcnt vmcnt(25)
    buffer_load_dwordx4 v84, s[12:15], s29 offen nt lds
    s_add_u32 m0, m0, s30
    s_waitcnt vmcnt(25)
    buffer_load_dwordx4 v85, s[12:15], s29 offen nt lds
    s_add_u32 m0, m0, s30
    s_waitcnt vmcnt(25)
    buffer_load_dwordx4 v86, s[12:15], s29 offen nt lds
    s_add_u32 m0, m0, s30
    s_waitcnt vmcnt(25)
    buffer_load_dwordx4 v87, s[12:15], s29 offen nt lds
    s_add_u32 m0, m0, s30
    s_add_u32 s31, s31, 4096
    s_xor_b32 s29, s31, s65
    s_add_u32 s29, s29, s61
    s_cmp_lt_u32 s31, 32768
    s_cbranch_scc1 L_ph2
    s_add_i32 s32, s32, 1
    s_mov_b32 m0, 65536
    s_mov_b32 s31, 0
    s_waitcnt lgkmcnt(0)
F_3:
    v_readfirstlane_b32 s7, v18
    v_readfirstlane_b32 s48, v19
    s_cmp_eq_u32 s48, 0
    s_cselect_b32 s7, 0, s7
    s_cmp_ge_u32 s7, 8
    s_cbranch_scc1 FE_4
    ds_read_b128 v[16:19], v10
    s_waitcnt lgkmcnt(0)
    s_sub_u32 s33, s33, 1
    s_cbranch_scc0 F_3
    s_mov_b32 s33, 0
FE_4:
    s_xor_b32 s29, s31, s69
    s_add_u32 s29, s29, s63
    s_nop 0
L_ph3:
    s_waitcnt vmcnt(21)
    buffer_load_dwordx4 v88, s[56:59], s29 offen nt lds
    s_add_u32 m0, m0, s30
    s_waitcnt vmcnt(21)
    buffer_load_dwordx4 v89, s[56:59], s29 offen nt lds
    s_add_u32 m0, m0, s30
    s_waitcnt vmcnt(21)
    buffer_load_dwordx4 v90, s[56:59], s29 offen nt lds
    s_add_u32 m0, m0, s30
    s_waitcnt vmcnt(21)
    buffer_load_dwordx4 v91, s[56:59], s29 offen nt lds
    s_add_u32 m0, m0, s30
    s_waitcnt vmcnt(21)
    buffer_load_dwordx4 v92, s[56:59], s29 offen nt lds
    s_add_u32 m0, m0, s30
    s_waitcnt vmcnt(21)
    buffer_load_dwordx4 v93, s[56:59], s29 offen nt lds
    s_add_u32 m0, m0, s30
    s_max_i32 s50, s50, s32
    v_mov_b32 v9, s50
    ds_write_b32 v8, v9
    s_add_i32 s32, s32, 1
    s_nop 0
    s_waitcnt vmcnt(21)
    buffer_load_dwordx4 v94, s[56:59], s29 offen nt lds
    s_add_u32 m0, m0, s30
    s_waitcnt vmcnt(21)
    buffer_load_dwordx4 v95, s[56:59], s29 offen nt lds
    s_add_u32 m0, m0, s30
    s_add_u32 s31, s31, 65536
    s_xor_b32 s29, s31, s69
    s_add_u32 s29, s29, s63
    s_cmp_lt_u32 s31, 524288
    s_cbranch_scc1 L_ph3
    s_cmp_eq_u32 s48, 1
    s_cbranch_scc0 L_tailg
    s_waitcnt vmcnt(16)
    v_mov_b32 v9, 30
    ds_write_b32 v8, v9
    s_waitcnt vmcnt(8)
    v_mov_b32 v9, 31
    ds_write_b32 v8, v9
    s_waitcnt vmcnt(0)
    v_mov_b32 v9, 32
    ds_write_b32 v8, v9
W_5:
    ds_read_b32 v3, v10 offset:40
    s_waitcnt lgkmcnt(0)
    v_readfirstlane_b32 s7, v3
    s_cmp_ge_u32 s7, 2
    s_cbranch_scc1 WE_6
    s_sub_u32 s33, s33, 1
    s_cbranch_scc0 W_5
    s_mov_b32 s33, 0
WE_6:
    s_branch L_fg
L_tailg:
    s_load_dwordx2 s[8:9], s[20:21], s23 offset:0 glc
    s_load_dwordx2 s[10:11], s[20:21], s23 offset:128 glc
    s_load_dwordx2 s[12:13], s[20:21], s23 offset:256 glc
    s_load_dwordx2 s[14:15], s[20:21], s23 offset:384 glc
    s_waitcnt vmcnt(16)
    v_mov_b32 v9, 30
    ds_write_b32 v8, v9
    s_waitcnt vmcnt(8)
    v_mov_b32 v9, 31
    ds_write_b32 v8, v9
    s_waitcnt vmcnt(0)
    v_mov_b32 v9, 32
    ds_write_b32 v8, v9
    s_barrier
L_h3:
    s_load_dwordx2 s[8:9], s[20:21], s23 offset:0 glc
    s_load_dwordx2 s[10:11], s[20:21], s23 offset:128 glc
    s_load_dwordx2 s[12:13], s[20:21], s23 offset:256 glc
    s_load_dwordx2 s[14:15], s[20:21], s23 offset:384 glc
    s_waitcnt lgkmcnt(0)
    s_cmp_eq_u64 s[8:9], s[16:17]
    s_cbranch_scc0 L_h3n
    s_cmp_eq_u64 s[10:11], s[16:17]
    s_cbranch_scc0 L_h3n
    s_cmp_eq_u64 s[12:13], s[16:17]
    s_cbranch_scc0 L_h3n
    s_cmp_eq_u64 s[14:15], s[16:17]
    s_cbranch_scc0 L_h3n
    s_branch L_h3e
L_h3n:
    s_sub_u32 s33, s33, 64
    s_cbranch_scc0 L_h3
    s_mov_b32 s33, 0
L_h3e:
L_fg:
    buffer_load_dwordx4 v[32:35], v24, s[36:39], s18 offen sc1
    buffer_load_dwordx4 v[36:39], v25, s[36:39], s18 offen sc1
    buffer_load_dwordx4 v[40:43], v26, s[36:39], s18 offen sc1
    buffer_load_dwordx4 v[44:47], v27, s[36:39], s18 offen sc1
    s_waitcnt vmcnt(3)
    v_xor_b32 v3, s25, v32
    v_bitop3_b32 v3, v33, s26, v3 bitop3:0xbe
    v_bitop3_b32 v3, v34, s27, v3 bitop3:0xbe
    v_bitop3_b32 v3, v35, s28, v3 bitop3:0xbe
    s_waitcnt vmcnt(2)
    v_bitop3_b32 v3, v36, s25, v3 bitop3:0xbe
    v_bitop3_b32 v3, v37, s26, v3 bitop3:0xbe
    v_bitop3_b32 v3, v38, s27, v3 bitop3:0xbe
    v_bitop3_b32 v3, v39, s28, v3 bitop3:0xbe
    v_pk_add_f32 v[28:29], v[32:33], v[36:37]
    v_pk_add_f32 v[30:31], v[34:35], v[38:39]
    s_waitcnt vmcnt(1)
    v_bitop3_b32 v3, v40, s25, v3 bitop3:0xbe
    v_bitop3_b32 v3, v41, s26, v3 bitop3:0xbe
    v_bitop3_b32 v3, v42, s27, v3 bitop3:0xbe
    v_bitop3_b32 v3, v43, s28, v3 bitop3:0xbe
    v_pk_add_f32 v[28:29], v[28:29], v[40:41]
    v_pk_add_f32 v[30:31], v[30:31], v[42:43]
    s_waitcnt vmcnt(0)
    v_bitop3_b32 v3, v44, s25, v3 bitop3:0xbe
    v_bitop3_b32 v3, v45, s26, v3 bitop3:0xbe
    v_bitop3_b32 v3, v46, s27, v3 bitop3:0xbe
    v_bitop3_b32 v3, v47, s28, v3 bitop3:0xbe
    v_pk_add_f32 v[28:29], v[28:29], v[44:45]
    v_pk_add_f32 v[30:31], v[30:31], v[46:47]
    v_and_b32 v3, 255, v3
    v_cmp_ne_u32 vcc, 0, v3
    s_cbranch_vccz L_fok
    s_sub_u32 s33, s33, 256
    s_cbranch_scc0 L_fg
    s_mov_b32 s33, 0
L_fok:
    v_permlane32_swap_b32 v28, v30
    v_permlane32_swap_b32 v29, v31
    s_nop 1
    v_add_f32 v28, v28, v30
    v_add_f32 v29, v29, v31
    s_nop 1
    v_permlane16_swap_b32 v28, v29
    s_nop 1
    v_add_f32 v28, v28, v29
    v_cvt_pk_bf16_f32 v28, v28, v28
    buffer_store_short v28, v14, s[40:43], s19 offen
    s_and_b32 s7, s2, 0xfb
    s_cmp_eq_u32 s7, 0
    s_cbranch_scc0 L_noep
    s_lshl_b32 s7, s5, 7
    v_mov_b32 v3, 0
    s_mov_b64 exec, 1
    buffer_store_dword v21, v3, s[36:39], s7 offen
L_noep:
    s_endpgm
L_waitprog:
    ds_read_b32 v3, v9
    s_waitcnt lgkmcnt(0)
    v_readfirstlane_b32 s50, v3
    s_cmp_ge_u32 s50, s51
    s_cbranch_scc1 L_wpr
    s_sub_u32 s33, s33, 1
    s_cbranch_scc0 L_waitprog
    s_mov_b32 s33, 0
L_wpr:
    s_setpc_b64 s[52:53]
L_compute:
    s_sub_u32 s23, s22, 1
    v_mov_b32 v10, 141824
    v_mov_b32 v11, 1
    v_mov_b32 v9, 142080
    s_mov_b32 s50, 0
    s_lshl_b32 s7, s5, 7
    s_waitcnt lgkmcnt(0)
    s_load_dword s24, s[20:21], s7
    s_mov_b32 s36, s20
    s_mov_b32 s37, s21
    s_mov_b32 s38, 4194304
    s_mov_b32 s39, 0x20000
    s_mov_b32 s42, 16384
    s_mov_b32 s43, 0x20000
    s_cmp_eq_u32 s23, 0
    s_cbranch_scc0 L_nox
    v_lshrrev_b32 v6, 5, v2
    v_and_b32 v7, 31, v2
    v_lshlrev_b32 v12, 1, v6
    v_xor_b32 v7, v7, v12
    v_lshrrev_b32 v12, 2, v7
    v_and_b32 v13, 1, v7
    v_lshl_or_b32 v12, v12, 1, v13
    v_and_b32 v7, 2, v7
    v_lshl_or_b32 v7, v7, 3, v12
    s_lshr_b32 s7, s66, 1
    v_xor_b32 v7, s7, v7
    v_lshlrev_b32 v7, 4, v7
    v_lshl_add_u32 v7, v6, 11, v7
    s_lshl_b32 s7, s34, 9
    s_mov_b32 m0, 137216
    v_mov_b32 v30, v7
    s_mov_b32 s57, s7
    v_xor_b32 v12, 0, v30
    buffer_load_dwordx4 v12, s[40:43], s57 offen lds
    v_xor_b32 v12, 32, v30
    v_add_u32 v12, 3072, v12
    buffer_load_dwordx4 v12, s[40:43], s57 offen offset:1024 lds
    v_xor_b32 v12, 64, v30
    v_add_u32 v12, 6144, v12
    buffer_load_dwordx4 v12, s[40:43], s57 offen offset:2048 lds
    v_xor_b32 v12, 96, v30
    v_add_u32 v12, 9216, v12
    buffer_load_dwordx4 v12, s[40:43], s57 offen offset:3072 lds
L_nox:
    v_bfe_u32 v6, v2, 2, 2
    v_and_b32 v7, 3, v2
    v_and_b32 v8, 7, v2
    v_and_b32 v12, 1, v4
    v_lshl_or_b32 v12, v12, 2, v6
    s_lshl_b32 s7, s23, 1
    v_xor_b32 v13, s7, v12
    v_lshlrev_b32 v13, 5, v13
    v_lshl_add_u32 v13, v7, 3, v13
    v_lshl_add_u32 v14, v4, 3, v6
    v_lshl_add_u32 v14, v14, 8, v13
    v_xor_b32 v15, 32, v14
    v_bfe_u32 v3, v2, 3, 1
    v_lshl_or_b32 v96, v3, 2, v7
    v_lshlrev_b32 v16, 1, v96
    v_xor_b32 v16, v16, v4
    v_lshlrev_b32 v16, 4, v16
    v_lshl_add_u32 v16, v96, 9, v16
    v_add_u32 v16, 137216, v16
    v_xor_b32 v17, 64, v16
    v_xor_b32 v18, 128, v16
    v_xor_b32 v19, 192, v16
    v_lshl_add_u32 v96, v4, 3, v96
    v_lshlrev_b32 v96, 4, v96
    v_add_u32 v96, 131072, v96
    v_lshl_add_u32 v20, v4, 3, v8
    v_lshlrev_b32 v20, 4, v20
    v_add_u32 v20, 131072, v20
    v_lshrrev_b32 v3, 5, v2
    v_and_b32 v97, 31, v2
    v_lshlrev_b32 v99, 4, v97
    v_lshl_add_u32 v99, v3, 12, v99
    v_lshlrev_b32 v97, 2, v97
    v_lshl_add_u32 v22, v3, 16, v97
    v_lshlrev_b32 v97, 4, v2
    s_lshl_b32 s56, s3, 17
    s_lshl_b32 s7, s35, 14
    s_add_u32 s70, s56, s7
    s_lshl_b32 s7, s23, 9
    s_add_u32 s70, s70, s7
    s_add_u32 s70, s70, 1048576
    s_add_u32 s71, s70, 8192
    s_lshl_b32 s7, s34, 12
    s_add_u32 s56, s56, s7
    s_lshl_b32 s7, s35, 9
    s_add_u32 s56, s56, s7
    s_lshl_b32 s7, s23, 7
    s_add_u32 s56, s56, s7
    s_add_u32 s56, s56, 1048576
    v_lshlrev_b32 v23, 9, v2
    s_lshl_b32 s55, s3, 12
    s_lshr_b32 s7, s4, 3
    s_lshl_b32 s7, s7, 7
    s_add_u32 s55, s55, s7
    s_and_b32 s7, s4, 7
    s_add_u32 s55, s55, s7
    s_waitcnt lgkmcnt(0)
    s_add_u32 s24, s24, 0x01010101
    s_mov_b32 s25, s24
    s_lshr_b32 s26, s24, 8
    s_lshr_b32 s27, s24, 16
    s_lshr_b32 s28, s24, 24
    v_mov_b32 v21, s24
    s_and_b32 s44, s24, 255
    s_mul_i32 s44, s44, 0x01010101
    s_mov_b32 s45, s44
    s_mov_b32 s29, 117835008
    s_mov_b32 s30, 117835009
    s_mov_b32 s31, 117835010
    s_mov_b32 s32, 117835011
    v_lshlrev_b32 v3, 3, v7
    v_lshrrev_b32 v98, v3, v21
    v_and_b32 v98, 255, v98
    s_mov_b32 s69, 0xffffff00
    s_mov_b32 s18, 0xffff
    s_mov_b32 s19, 0xffff
    v_cmp_gt_u32 s[46:47], 8, v5
    s_cmp_eq_u32 s23, 0
    s_cbranch_scc0 L_nox2
    s_waitcnt vmcnt(0)
    s_mov_b64 exec, 1
    ds_add_u32 v10, v11 offset:0
    s_mov_b64 exec, -1
L_nox2:
    s_cmp_eq_u32 s23, 5
    s_cbranch_scc0 L_nomode
    s_getreg_b32 s16, hwreg(HW_REG_XCC_ID, 0, 3)
    s_and_b32 s17, s24, -8
    s_or_b32 s16, s16, s17
    s_mov_b32 s17, s16
    s_lshl_b32 s58, s3, 9
    s_add_u32 s58, s58, 196608
    s_cmp_ge_u32 s50, 2
    s_cbranch_scc1 PE_7
    s_mov_b32 s51, 2
    s_call_b64 s[52:53], L_waitprog
PE_7:
    s_load_dwordx8 s[8:15], s[20:21], s58 offset:0
    s_load_dwordx8 s[60:67], s[20:21], s58 offset:128
    s_load_dwordx8 s[80:87], s[20:21], s58 offset:256
    s_load_dwordx8 s[88:95], s[20:21], s58 offset:384
    s_waitcnt lgkmcnt(0)
    s_xor_b64 s[52:53], s[8:9], s[16:17]
    s_xor_b64 s[10:11], s[10:11], s[16:17]
    s_or_b64 s[52:53], s[52:53], s[10:11]
    s_xor_b64 s[12:13], s[12:13], s[16:17]
    s_or_b64 s[52:53], s[52:53], s[12:13]
    s_xor_b64 s[14:15], s[14:15], s[16:17]
    s_or_b64 s[52:53], s[52:53], s[14:15]
    s_xor_b64 s[60:61], s[60:61], s[16:17]
    s_or_b64 s[52:53], s[52:53], s[60:61]
    s_xor_b64 s[62:63], s[62:63], s[16:17]
    s_or_b64 s[52:53], s[52:53], s[62:63]
    s_xor_b64 s[64:65], s[64:65], s[16:17]
    s_or_b64 s[52:53], s[52:53], s[64:65]
    s_xor_b64 s[66:67], s[66:67], s[16:17]
    s_or_b64 s[52:53], s[52:53], s[66:67]
    s_xor_b64 s[80:81], s[80:81], s[16:17]
    s_or_b64 s[52:53], s[52:53], s[80:81]
    s_xor_b64 s[82:83], s[82:83], s[16:17]
    s_or_b64 s[52:53], s[52:53], s[82:83]
    s_xor_b64 s[84:85], s[84:85], s[16:17]
    s_or_b64 s[52:53], s[52:53], s[84:85]
    s_xor_b64 s[86:87], s[86:87], s[16:17]
    s_or_b64 s[52:53], s[52:53], s[86:87]
    s_xor_b64 s[88:89], s[88:89], s[16:17]
    s_or_b64 s[52:53], s[52:53], s[88:89]
    s_xor_b64 s[90:91], s[90:91], s[16:17]
    s_or_b64 s[52:53], s[52:53], s[90:91]
    s_xor_b64 s[92:93], s[92:93], s[16:17]
    s_or_b64 s[52:53], s[52:53], s[92:93]
    s_xor_b64 s[94:95], s[94:95], s[16:17]
    s_or_b64 s[52:53], s[52:53], s[94:95]
    s_or_b32 s7, s52, s53
    s_cmp_lt_u32 s7, 8
    s_cbranch_scc1 L_mdr
L_md:
    s_sleep 4
    s_load_dwordx8 s[8:15], s[20:21], s58 offset:0 glc
    s_load_dwordx8 s[60:67], s[20:21], s58 offset:128 glc
    s_load_dwordx8 s[80:87], s[20:21], s58 offset:256 glc
    s_load_dwordx8 s[88:95], s[20:21], s58 offset:384 glc
    s_waitcnt lgkmcnt(0)
    s_xor_b64 s[52:53], s[8:9], s[16:17]
    s_xor_b64 s[10:11], s[10:11], s[16:17]
    s_or_b64 s[52:53], s[52:53], s[10:11]
    s_xor_b64 s[12:13], s[12:13], s[16:17]
    s_or_b64 s[52:53], s[52:53], s[12:13]
    s_xor_b64 s[14:15], s[14:15], s[16:17]
    s_or_b64 s[52:53], s[52:53], s[14:15]
    s_xor_b64 s[60:61], s[60:61], s[16:17]
    s_or_b64 s[52:53], s[52:53], s[60:61]
    s_xor_b64 s[62:63], s[62:63], s[16:17]
    s_or_b64 s[52:53], s[52:53], s[62:63]
    s_xor_b64 s[64:65], s[64:65], s[16:17]
    s_or_b64 s[52:53], s[52:53], s[64:65]
    s_xor_b64 s[66:67], s[66:67], s[16:17]
    s_or_b64 s[52:53], s[52:53], s[66:67]
    s_xor_b64 s[80:81], s[80:81], s[16:17]
    s_or_b64 s[52:53], s[52:53], s[80:81]
    s_xor_b64 s[82:83], s[82:83], s[16:17]
    s_or_b64 s[52:53], s[52:53], s[82:83]
    s_xor_b64 s[84:85], s[84:85], s[16:17]
    s_or_b64 s[52:53], s[52:53], s[84:85]
    s_xor_b64 s[86:87], s[86:87], s[16:17]
    s_or_b64 s[52:53], s[52:53], s[86:87]
    s_xor_b64 s[88:89], s[88:89], s[16:17]
    s_or_b64 s[52:53], s[52:53], s[88:89]
    s_xor_b64 s[90:91], s[90:91], s[16:17]
    s_or_b64 s[52:53], s[52:53], s[90:91]
    s_xor_b64 s[92:93], s[92:93], s[16:17]
    s_or_b64 s[52:53], s[52:53], s[92:93]
    s_xor_b64 s[94:95], s[94:95], s[16:17]
    s_or_b64 s[52:53], s[52:53], s[94:95]
    s_or_b32 s7, s52, s53
    s_cmp_lt_u32 s7, 8
    s_cbranch_scc1 L_mdr
    s_sub_u32 s33, s33, 64
    s_cbranch_scc0 L_md
    s_mov_b32 s33, 0
L_mdr:
    s_cmp_eq_u32 s7, 0
    s_cselect_b32 s7, 1, 2
    v_mov_b32 v3, s7
    s_mov_b64 exec, 1
    ds_write_b32 v10, v3 offset:12
    s_mov_b64 exec, -1
L_nomode:
    s_cmp_lt_u32 s23, 4
    s_cbranch_scc0 L_s1done
    s_add_u32 s64, s56, 16384
    s_add_u32 s65, s56, 32768
    s_add_u32 s66, s56, 49152
W_8:
    ds_read_b32 v3, v10 offset:0
    s_waitcnt lgkmcnt(0)
    v_readfirstlane_b32 s7, v3
    s_cmp_ge_u32 s7, 1
    s_cbranch_scc1 WE_9
    s_sub_u32 s33, s33, 1
    s_cbranch_scc0 W_8
    s_mov_b32 s33, 0
WE_9:
    ds_read_b128 v[32:35], v16 offset:0
    ds_read_b128 v[36:39], v17 offset:0
    ds_read_b128 v[40:43], v18 offset:0
    ds_read_b128 v[44:47], v19 offset:0
    ds_read_b128 v[48:51], v16 offset:256
    ds_read_b128 v[52:55], v17 offset:256
    ds_read_b128 v[56:59], v18 offset:256
    ds_read_b128 v[60:63], v19 offset:256
    s_cmp_ge_u32 s50, 1
    s_cbranch_scc1 PE_10
    s_mov_b32 s51, 1
    s_call_b64 s[52:53], L_waitprog
PE_10:
    ds_read_b64_tr_b16 v[64:65], v14 offset:0
    ds_read_b64_tr_b16 v[66:67], v14 offset:1024
    ds_read_b64_tr_b16 v[68:69], v15 offset:0
    ds_read_b64_tr_b16 v[70:71], v15 offset:1024
    s_cmp_ge_u32 s50, 2
    s_cbranch_scc1 PE_11
    s_mov_b32 s51, 2
    s_call_b64 s[52:53], L_waitprog
PE_11:
    ds_read_b64_tr_b16 v[72:73], v14 offset:8192
    ds_read_b64_tr_b16 v[74:75], v14 offset:9216
    ds_read_b64_tr_b16 v[76:77], v15 offset:8192
    ds_read_b64_tr_b16 v[78:79], v15 offset:9216
    s_waitcnt lgkmcnt(4)
    v_mfma_f32_16x16x32_bf16 v[24:27], v[32:35], v[64:67], 0
    v_mfma_f32_16x16x32_bf16 v[28:31], v[32:35], v[68:71], 0
    s_cmp_ge_u32 s50, 3
    s_cbranch_scc1 PE_12
    s_mov_b32 s51, 3
    s_call_b64 s[52:53], L_waitprog
PE_12:
    ds_read_b64_tr_b16 v[64:65], v14 offset:16384
    ds_read_b64_tr_b16 v[66:67], v14 offset:17408
    ds_read_b64_tr_b16 v[68:69], v15 offset:16384
    ds_read_b64_tr_b16 v[70:71], v15 offset:17408
    s_waitcnt lgkmcnt(4)
    v_mfma_f32_16x16x32_bf16 v[24:27], v[36:39], v[72:75], v[24:27]
    v_mfma_f32_16x16x32_bf16 v[28:31], v[36:39], v[76:79], v[28:31]
    s_cmp_ge_u32 s50, 4
    s_cbranch_scc1 PE_13
    s_mov_b32 s51, 4
    s_call_b64 s[52:53], L_waitprog
PE_13:
    ds_read_b64_tr_b16 v[72:73], v14 offset:24576
    ds_read_b64_tr_b16 v[74:75], v14 offset:25600
    ds_read_b64_tr_b16 v[76:77], v15 offset:24576
    ds_read_b64_tr_b16 v[78:79], v15 offset:25600
    s_waitcnt lgkmcnt(4)
    v_mfma_f32_16x16x32_bf16 v[24:27], v[40:43], v[64:67], v[24:27]
    v_mfma_f32_16x16x32_bf16 v[28:31], v[40:43], v[68:71], v[28:31]
    s_cmp_ge_u32 s50, 5
    s_cbranch_scc1 PE_14
    s_mov_b32 s51, 5
    s_call_b64 s[52:53], L_waitprog
PE_14:
    ds_read_b64_tr_b16 v[64:65], v14 offset:32768
    ds_read_b64_tr_b16 v[66:67], v14 offset:33792
    ds_read_b64_tr_b16 v[68:69], v15 offset:32768
    ds_read_b64_tr_b16 v[70:71], v15 offset:33792
    s_waitcnt lgkmcnt(4)
    v_mfma_f32_16x16x32_bf16 v[24:27], v[44:47], v[72:75], v[24:27]
    v_mfma_f32_16x16x32_bf16 v[28:31], v[44:47], v[76:79], v[28:31]
    s_cmp_ge_u32 s50, 6
    s_cbranch_scc1 PE_15
    s_mov_b32 s51, 6
    s_call_b64 s[52:53], L_waitprog
PE_15:
    ds_read_b64_tr_b16 v[72:73], v14 offset:40960
    ds_read_b64_tr_b16 v[74:75], v14 offset:41984
    ds_read_b64_tr_b16 v[76:77], v15 offset:40960
    ds_read_b64_tr_b16 v[78:79], v15 offset:41984
    s_waitcnt lgkmcnt(4)
    v_mfma_f32_16x16x32_bf16 v[24:27], v[48:51], v[64:67], v[24:27]
    v_mfma_f32_16x16x32_bf16 v[28:31], v[48:51], v[68:71], v[28:31]
    s_cmp_ge_u32 s50, 7
    s_cbranch_scc1 PE_16
    s_mov_b32 s51, 7
    s_call_b64 s[52:53], L_waitprog
PE_16:
    ds_read_b64_tr_b16 v[64:65], v14 offset:49152
    ds_read_b64_tr_b16 v[66:67], v14 offset:50176
    ds_read_b64_tr_b16 v[68:69], v15 offset:49152
    ds_read_b64_tr_b16 v[70:71], v15 offset:50176
    s_waitcnt lgkmcnt(4)
    v_mfma_f32_16x16x32_bf16 v[24:27], v[52:55], v[72:75], v[24:27]
    v_mfma_f32_16x16x32_bf16 v[28:31], v[52:55], v[76:79], v[28:31]
    s_cmp_ge_u32 s50, 8
    s_cbranch_scc1 PE_17
    s_mov_b32 s51, 8
    s_call_b64 s[52:53], L_waitprog
PE_17:
    ds_read_b64_tr_b16 v[72:73], v14 offset:57344
    ds_read_b64_tr_b16 v[74:75], v14 offset:58368
    ds_read_b64_tr_b16 v[76:77], v15 offset:57344
    ds_read_b64_tr_b16 v[78:79], v15 offset:58368
    s_waitcnt lgkmcnt(4)
    v_mfma_f32_16x16x32_bf16 v[24:27], v[56:59], v[64:67], v[24:27]
    v_mfma_f32_16x16x32_bf16 v[28:31], v[56:59], v[68:71], v[28:31]
    s_waitcnt lgkmcnt(0)
    v_mfma_f32_16x16x32_bf16 v[24:27], v[60:63], v[72:75], v[24:27]
    v_mfma_f32_16x16x32_bf16 v[28:31], v[60:63], v[76:79], v[28:31]
    s_mov_b64 exec, 1
    ds_add_u32 v10, v11 offset:4
    s_mov_b64 exec, -1
    s_nop 1
W_18:
    ds_read_b32 v3, v10 offset:12
    s_waitcnt lgkmcnt(0)
    v_readfirstlane_b32 s48, v3
    s_cmp_ge_u32 s48, 1
    s_cbranch_scc1 WE_19
    s_sub_u32 s33, s33, 1
    s_cbranch_scc0 W_18
    s_mov_b32 s33, 0
WE_19:
    v_cndmask_b32 v24, v28, v24, s[18:19]
    v_cndmask_b32 v25, v29, v25, s[18:19]
    v_cndmask_b32 v26, v30, v26, s[18:19]
    v_cndmask_b32 v27, v31, v27, s[18:19]
    v_and_or_b32 v24, v24, s69, v98
    v_and_or_b32 v25, v25, s69, v98
    v_and_or_b32 v26, v26, s69, v98
    v_and_or_b32 v27, v27, s69, v98
    s_cmp_eq_u32 s48, 1
    s_cbranch_scc0 M_20
    buffer_store_dword v24, v22, s[36:39], s56 offen
    buffer_store_dword v25, v22, s[36:39], s64 offen
    buffer_store_dword v26, v22, s[36:39], s65 offen
    buffer_store_dword v27, v22, s[36:39], s66 offen
    s_branch ME_21
M_20:
    buffer_store_dword v24, v22, s[36:39], s56 offen sc1
    buffer_store_dword v25, v22, s[36:39], s64 offen sc1
    buffer_store_dword v26, v22, s[36:39], s65 offen sc1
    buffer_store_dword v27, v22, s[36:39], s66 offen sc1
ME_21:
    s_cmp_eq_u32 s48, 1
    s_cbranch_scc1 L_s1done
    s_mov_b64 exec, 1
    ds_add_rtn_u32 v3, v10, v11 offset:16
    s_mov_b64 exec, -1
    s_add_u32 s49, s55, 65536
    s_waitcnt lgkmcnt(0)
    v_readfirstlane_b32 s7, v3
    s_cmp_eq_u32 s7, 3
    s_cbranch_scc0 NF_22
    s_mov_b64 exec, 255
    buffer_store_byte v21, v23, s[36:39], s49 offen sc1
    s_mov_b64 exec, -1
NF_22:
L_s1done:
    v_and_b32 v19, 31, v2
    v_lshrrev_b32 v17, 1, v19
    v_lshlrev_b32 v17, 7, v17
    v_and_b32 v3, 1, v19
    v_lshl_add_u32 v17, v3, 3, v17
    s_lshl_b32 s7, s23, 4
    s_add_u32 s7, s7, 131072
    v_add_u32 v17, s7, v17
    v_xor_b32 v18, v4, v5
    v_lshlrev_b32 v18, 4, v18
    v_lshl_add_u32 v18, v5, 8, v18
    s_lshl_b32 s7, s23, 13
    s_add_u32 s7, s7, 65536
    v_add_u32 v18, s7, v18
    v_lshl_add_u32 v14, v4, 2, v6
    v_lshl_add_u32 v14, v14, 8, v13
    v_xor_b32 v15, 32, v14
W_23:
    ds_read_b32 v3, v10 offset:12
    s_waitcnt lgkmcnt(0)
    v_readfirstlane_b32 s48, v3
    s_cmp_ge_u32 s48, 1
    s_cbranch_scc1 WE_24
    s_sub_u32 s33, s33, 1
    s_cbranch_scc0 W_23
    s_mov_b32 s33, 0
WE_24:
    s_cmp_eq_u32 s48, 1
    s_cbranch_scc0 L_h1g
    s_cmp_ge_u32 s50, 10
    s_cbranch_scc1 PE_25
    s_mov_b32 s51, 10
    s_call_b64 s[52:53], L_waitprog
PE_25:
    s_branch L_h1d
L_h1g:
    s_cmp_eq_u32 s23, 4
    s_cbranch_scc0 L_h1o
    s_lshl_b32 s58, s3, 12
    s_lshl_b32 s7, s35, 9
    s_add_u32 s58, s58, s7
    s_add_u32 s58, s58, 65536
    s_cmp_ge_u32 s50, 10
    s_cbranch_scc1 PE_26
    s_mov_b32 s51, 10
    s_call_b64 s[52:53], L_waitprog
PE_26:
L_h1:
    s_load_dwordx2 s[8:9], s[20:21], s58 offset:0 glc
    s_load_dwordx2 s[10:11], s[20:21], s58 offset:128 glc
    s_load_dwordx2 s[12:13], s[20:21], s58 offset:256 glc
    s_load_dwordx2 s[14:15], s[20:21], s58 offset:384 glc
    s_waitcnt lgkmcnt(0)
    s_cmp_eq_u64 s[8:9], s[44:45]
    s_cbranch_scc0 L_h1n
    s_cmp_eq_u64 s[10:11], s[44:45]
    s_cbranch_scc0 L_h1n
    s_cmp_eq_u64 s[12:13], s[44:45]
    s_cbranch_scc0 L_h1n
    s_cmp_eq_u64 s[14:15], s[44:45]
    s_cbranch_scc0 L_h1n
    s_branch L_h1e
L_h1n:
    s_sleep 6
    s_sub_u32 s33, s33, 64
    s_cbranch_scc0 L_h1
    s_mov_b32 s33, 0
L_h1e:
    s_mov_b64 exec, 1
    ds_add_u32 v10, v11 offset:36
    s_mov_b64 exec, -1
    s_branch L_h1d
L_h1o:
W_27:
    ds_read_b32 v3, v10 offset:36
    s_waitcnt lgkmcnt(0)
    v_readfirstlane_b32 s7, v3
    s_cmp_ge_u32 s7, 1
    s_cbranch_scc1 WE_28
    s_sub_u32 s33, s33, 1
    s_cbranch_scc0 W_27
    s_mov_b32 s33, 0
WE_28:
L_h1d:
    buffer_load_dwordx4 v[64:67], v99, s[36:39], s70 offen sc1
    buffer_load_dwordx4 v[68:71], v99, s[36:39], s71 offen sc1
    s_branch L_qw
L_qg:
    buffer_load_dwordx4 v[64:67], v99, s[36:39], s70 offen sc1
    buffer_load_dwordx4 v[68:71], v99, s[36:39], s71 offen sc1
L_qw:
    s_waitcnt vmcnt(0)
    v_xor_b32 v3, s25, v64
    v_bitop3_b32 v3, v65, s26, v3 bitop3:0xbe
    v_bitop3_b32 v3, v66, s27, v3 bitop3:0xbe
    v_bitop3_b32 v3, v67, s28, v3 bitop3:0xbe
    v_bitop3_b32 v3, v68, s25, v3 bitop3:0xbe
    v_bitop3_b32 v3, v69, s26, v3 bitop3:0xbe
    v_bitop3_b32 v3, v70, s27, v3 bitop3:0xbe
    v_bitop3_b32 v3, v71, s28, v3 bitop3:0xbe
    v_and_b32 v3, 255, v3
    v_cmp_ne_u32 vcc, 0, v3
    s_cbranch_vccz L_qok
    s_sub_u32 s33, s33, 256
    s_cbranch_scc0 L_qg
    s_mov_b32 s33, 0
L_qok:
    v_pk_add_f32 v[64:65], v[64:65], v[68:69]
    v_pk_add_f32 v[66:67], v[66:67], v[70:71]
    v_mov_b32 v68, v64
    v_mov_b32 v69, v65
    v_mov_b32 v70, v66
    v_mov_b32 v71, v67
    s_nop 1
    v_permlane32_swap_b32 v64, v68
    v_permlane32_swap_b32 v65, v69
    v_permlane32_swap_b32 v66, v70
    v_permlane32_swap_b32 v67, v71
    s_nop 1
    v_pk_add_f32 v[64:65], v[64:65], v[68:69]
    v_pk_add_f32 v[66:67], v[66:67], v[70:71]
    v_cvt_pk_bf16_f32 v64, v64, v65
    v_cvt_pk_bf16_f32 v65, v66, v67
    s_mov_b64 exec, 0xffffffff
    ds_write_b64 v17, v[64:65]
    s_waitcnt lgkmcnt(0)
    s_mov_b64 exec, 1
    ds_add_u32 v10, v11 offset:20
    s_mov_b64 exec, -1
    s_add_u32 s51, s23, 9
    s_call_b64 s[52:53], L_waitprog
    ds_read_b128 v[32:35], v18 offset:0
    ds_read_b128 v[48:51], v18 offset:4096
    v_xor_b32 v19, 64, v18
    ds_read_b128 v[36:39], v19 offset:0
    ds_read_b128 v[52:55], v19 offset:4096
    v_xor_b32 v19, 128, v18
    ds_read_b128 v[40:43], v19 offset:0
    ds_read_b128 v[56:59], v19 offset:4096
    v_xor_b32 v19, 192, v18
    ds_read_b128 v[44:47], v19 offset:0
    ds_read_b128 v[60:63], v19 offset:4096
    s_waitcnt lgkmcnt(0)
    s_mov_b64 exec, 1
    ds_add_u32 v10, v11 offset:8
    s_mov_b64 exec, -1
    s_mov_b32 s59, 1040356334
    v_lshlrev_b32 v16, 5, v8
    v_add_u32 v16, 141312, v16
    s_lshl_b32 s7, s23, 2
    v_add_u32 v17, s7, v16
    s_lshl_b32 s7, s23, 9
    s_add_u32 s7, s7, 2048
    v_add_u32 v18, s7, v20
W_29:
    ds_read_b32 v3, v10 offset:20
    s_waitcnt lgkmcnt(0)
    v_readfirstlane_b32 s7, v3
    s_cmp_ge_u32 s7, 8
    s_cbranch_scc1 WE_30
    s_sub_u32 s33, s33, 1
    s_cbranch_scc0 W_29
    s_mov_b32 s33, 0
WE_30:
    ds_read_b128 v[64:67], v20 offset:0
    ds_read_b128 v[68:71], v20 offset:512
    ds_read_b128 v[72:75], v20 offset:1024
    ds_read_b128 v[76:79], v20 offset:1536
    s_waitcnt lgkmcnt(3)
    v_mfma_f32_16x16x32_bf16 v[24:27], v[32:35], v[64:67], 0
    v_mfma_f32_16x16x32_bf16 v[28:31], v[48:51], v[64:67], 0
    s_waitcnt lgkmcnt(2)
    v_mfma_f32_16x16x32_bf16 v[24:27], v[36:39], v[68:71], v[24:27]
    v_mfma_f32_16x16x32_bf16 v[28:31], v[52:55], v[68:71], v[28:31]
    s_waitcnt lgkmcnt(1)
    v_mfma_f32_16x16x32_bf16 v[24:27], v[40:43], v[72:75], v[24:27]
    v_mfma_f32_16x16x32_bf16 v[28:31], v[56:59], v[72:75], v[28:31]
    s_waitcnt lgkmcnt(0)
    v_mfma_f32_16x16x32_bf16 v[24:27], v[44:47], v[76:79], v[24:27]
    v_mfma_f32_16x16x32_bf16 v[28:31], v[60:63], v[76:79], v[28:31]
    s_lshl_b32 s56, s3, 16
    s_lshl_b32 s7, s4, 8
    s_add_u32 s56, s56, s7
    s_lshl_b32 s7, s23, 6
    s_add_u32 s56, s56, s7
    s_add_u32 s56, s56, 2097152
    s_nop 1
    v_max3_f32 v64, v24, v25, v26
    v_max3_f32 v64, v64, v27, v28
    v_max3_f32 v64, v64, v29, v30
    v_max_f32 v64, v64, v31
    v_mov_b32 v65, v64
    s_nop 1
    v_permlane32_swap_b32 v64, v65
    s_nop 1
    v_max_f32 v64, v64, v65
    v_mov_b32 v65, v64
    s_nop 1
    v_permlane16_swap_b32 v64, v65
    s_nop 1
    v_max_f32 v64, v64, v65
    s_mov_b64 exec, 0xff
    ds_write_b32 v17, v64
    s_waitcnt lgkmcnt(0)
    s_mov_b64 exec, 1
    ds_add_u32 v10, v11 offset:24
    s_mov_b64 exec, -1
W_31:
    ds_read_b32 v3, v10 offset:24
    s_waitcnt lgkmcnt(0)
    v_readfirstlane_b32 s7, v3
    s_cmp_ge_u32 s7, 8
    s_cbranch_scc1 WE_32
    s_sub_u32 s33, s33, 1
    s_cbranch_scc0 W_31
    s_mov_b32 s33, 0
WE_32:
    ds_read_b128 v[64:67], v16
    ds_read_b128 v[68:71], v16 offset:16
    s_waitcnt lgkmcnt(0)
    v_max3_f32 v64, v64, v65, v66
    v_max3_f32 v64, v64, v67, v68
    v_max3_f32 v64, v64, v69, v70
    v_max_f32 v72, v64, v71
    v_sub_f32 v24, v24, v72
    v_sub_f32 v25, v25, v72
    v_sub_f32 v26, v26, v72
    v_sub_f32 v27, v27, v72
    v_sub_f32 v28, v28, v72
    v_sub_f32 v29, v29, v72
    v_sub_f32 v30, v30, v72
    v_sub_f32 v31, v31, v72
    v_mul_f32 v24, s59, v24
    v_mul_f32 v25, s59, v25
    v_mul_f32 v26, s59, v26
    v_mul_f32 v27, s59, v27
    v_mul_f32 v28, s59, v28
    v_mul_f32 v29, s59, v29
    v_mul_f32 v30, s59, v30
    v_mul_f32 v31, s59, v31
    v_exp_f32 v24, v24
    v_exp_f32 v25, v25
    v_exp_f32 v26, v26
    v_exp_f32 v27, v27
    v_exp_f32 v28, v28
    v_exp_f32 v29, v29
    v_exp_f32 v30, v30
    v_exp_f32 v31, v31
    s_nop 0
    v_cvt_pk_bf16_f32 v64, v24, v25
    v_cvt_pk_bf16_f32 v65, v26, v27
    v_cvt_pk_bf16_f32 v66, v28, v29
    v_cvt_pk_bf16_f32 v67, v30, v31
    s_mov_b64 exec, s[46:47]
    ds_write_b128 v18, v[64:67]
    s_mov_b64 exec, -1
    v_pk_add_f32 v[24:25], v[24:25], v[26:27]
    v_pk_add_f32 v[28:29], v[28:29], v[30:31]
    v_pk_add_f32 v[24:25], v[24:25], v[28:29]
    v_add_f32 v24, v24, v25
    v_mov_b32 v25, v24
    s_nop 1
    v_permlane32_swap_b32 v24, v25
    s_nop 1
    v_add_f32 v24, v24, v25
    v_mov_b32 v25, v24
    s_nop 1
    v_permlane16_swap_b32 v24, v25
    s_nop 1
    v_add_f32 v24, v24, v25
    s_mov_b64 exec, 0xff
    ds_write_b32 v17, v24 offset:256
    s_waitcnt lgkmcnt(0)
    s_mov_b64 exec, 1
    ds_add_u32 v10, v11 offset:28
    s_mov_b64 exec, -1
    s_lshl_b32 s60, s3, 5
    s_add_u32 s60, s60, s4
    s_lshl_b32 s60, s60, 12
    s_lshl_b32 s7, s23, 10
    s_add_u32 s60, s60, s7
    s_add_u32 s60, s60, 1048576
    s_cmp_lt_u32 s23, 4
    s_cbranch_scc0 L_npv
    s_setprio 1
    v_lshlrev_b32 v16, 1, v8
    v_xor_b32 v16, v16, v4
    v_lshlrev_b32 v16, 4, v16
    v_lshl_add_u32 v16, v8, 9, v16
    v_add_u32 v132, 137216, v16
    v_xor_b32 v133, 64, v132
    v_xor_b32 v134, 128, v132
    v_xor_b32 v135, 192, v132
    v_lshrrev_b32 v16, 3, v2
    v_bfe_u32 v17, v2, 2, 1
    v_lshl_add_u32 v17, v17, 3, v16
    v_lshl_add_u32 v17, v7, 4, v17
    v_lshlrev_b32 v17, 2, v17
    v_lshlrev_b32 v18, 6, v16
    v_lshl_add_u32 v18, v7, 4, v18
    s_lshl_b32 s63, s3, 12
    s_add_u32 s63, s63, 3145728
    v_lshlrev_b32 v16, 13, v16
    v_lshl_add_u32 v16, v8, 3, v16
W_33:
    ds_read_b32 v3, v10 offset:28
    s_waitcnt lgkmcnt(0)
    v_readfirstlane_b32 s7, v3
    s_cmp_ge_u32 s7, 8
    s_cbranch_scc1 WE_34
    s_sub_u32 s33, s33, 1
    s_cbranch_scc0 W_33
    s_mov_b32 s33, 0
WE_34:
    ds_read_b128 v[32:35], v20 offset:2048
    ds_read_b128 v[36:39], v20 offset:2560
    ds_read_b128 v[40:43], v20 offset:3072
    ds_read_b128 v[44:47], v20 offset:3584
    ds_read_b128 v[48:51], v20 offset:4096
    ds_read_b128 v[52:55], v20 offset:4608
    ds_read_b128 v[56:59], v20 offset:5120
    ds_read_b128 v[60:63], v20 offset:5632
    s_cmp_ge_u32 s50, 17
    s_cbranch_scc1 PE_35
    s_mov_b32 s51, 17
    s_call_b64 s[52:53], L_waitprog
PE_35:
    ds_read_b64_tr_b16 v[64:65], v14 offset:0
    ds_read_b64_tr_b16 v[66:67], v14 offset:4096
    ds_read_b64_tr_b16 v[68:69], v15 offset:0
    ds_read_b64_tr_b16 v[70:71], v15 offset:4096
    s_cmp_ge_u32 s50, 18
    s_cbranch_scc1 PE_36
    s_mov_b32 s51, 18
    s_call_b64 s[52:53], L_waitprog
PE_36:
    ds_read_b64_tr_b16 v[72:73], v14 offset:8192
    ds_read_b64_tr_b16 v[74:75], v14 offset:12288
    ds_read_b64_tr_b16 v[76:77], v15 offset:8192
    ds_read_b64_tr_b16 v[78:79], v15 offset:12288
    s_waitcnt lgkmcnt(4)
    v_mfma_f32_16x16x32_bf16 v[24:27], v[64:67], v[32:35], 0
    v_mfma_f32_16x16x32_bf16 v[28:31], v[68:71], v[32:35], 0
    s_cmp_ge_u32 s50, 19
    s_cbranch_scc1 PE_37
    s_mov_b32 s51, 19
    s_call_b64 s[52:53], L_waitprog
PE_37:
    ds_read_b64_tr_b16 v[64:65], v14 offset:16384
    ds_read_b64_tr_b16 v[66:67], v14 offset:20480
    ds_read_b64_tr_b16 v[68:69], v15 offset:16384
    ds_read_b64_tr_b16 v[70:71], v15 offset:20480
    s_waitcnt lgkmcnt(4)
    v_mfma_f32_16x16x32_bf16 v[24:27], v[72:75], v[36:39], v[24:27]
    v_mfma_f32_16x16x32_bf16 v[28:31], v[76:79], v[36:39], v[28:31]
    s_cmp_ge_u32 s50, 20
    s_cbranch_scc1 PE_38
    s_mov_b32 s51, 20
    s_call_b64 s[52:53], L_waitprog
PE_38:
    ds_read_b64_tr_b16 v[72:73], v14 offset:24576
    ds_read_b64_tr_b16 v[74:75], v14 offset:28672
    ds_read_b64_tr_b16 v[76:77], v15 offset:24576
    ds_read_b64_tr_b16 v[78:79], v15 offset:28672
    s_waitcnt lgkmcnt(4)
    v_mfma_f32_16x16x32_bf16 v[24:27], v[64:67], v[40:43], v[24:27]
    v_mfma_f32_16x16x32_bf16 v[28:31], v[68:71], v[40:43], v[28:31]
    s_cmp_ge_u32 s50, 21
    s_cbranch_scc1 PE_39
    s_mov_b32 s51, 21
    s_call_b64 s[52:53], L_waitprog
PE_39:
    ds_read_b64_tr_b16 v[64:65], v14 offset:32768
    ds_read_b64_tr_b16 v[66:67], v14 offset:36864
    ds_read_b64_tr_b16 v[68:69], v15 offset:32768
    ds_read_b64_tr_b16 v[70:71], v15 offset:36864
    s_waitcnt lgkmcnt(4)
    v_mfma_f32_16x16x32_bf16 v[24:27], v[72:75], v[44:47], v[24:27]
    v_mfma_f32_16x16x32_bf16 v[28:31], v[76:79], v[44:47], v[28:31]
    s_cmp_ge_u32 s50, 22
    s_cbranch_scc1 PE_40
    s_mov_b32 s51, 22
    s_call_b64 s[52:53], L_waitprog
PE_40:
    ds_read_b64_tr_b16 v[72:73], v14 offset:40960
    ds_read_b64_tr_b16 v[74:75], v14 offset:45056
    ds_read_b64_tr_b16 v[76:77], v15 offset:40960
    ds_read_b64_tr_b16 v[78:79], v15 offset:45056
    s_waitcnt lgkmcnt(4)
    v_mfma_f32_16x16x32_bf16 v[24:27], v[64:67], v[48:51], v[24:27]
    v_mfma_f32_16x16x32_bf16 v[28:31], v[68:71], v[48:51], v[28:31]
    s_cmp_ge_u32 s50, 23
    s_cbranch_scc1 PE_41
    s_mov_b32 s51, 23
    s_call_b64 s[52:53], L_waitprog
PE_41:
    ds_read_b64_tr_b16 v[64:65], v14 offset:49152
    ds_read_b64_tr_b16 v[66:67], v14 offset:53248
    ds_read_b64_tr_b16 v[68:69], v15 offset:49152
    ds_read_b64_tr_b16 v[70:71], v15 offset:53248
    s_waitcnt lgkmcnt(4)
    v_mfma_f32_16x16x32_bf16 v[24:27], v[72:75], v[52:55], v[24:27]
    v_mfma_f32_16x16x32_bf16 v[28:31], v[76:79], v[52:55], v[28:31]
    s_cmp_ge_u32 s50, 24
    s_cbranch_scc1 PE_42
    s_mov_b32 s51, 24
    s_call_b64 s[52:53], L_waitprog
PE_42:
    ds_read_b64_tr_b16 v[72:73], v14 offset:57344
    ds_read_b64_tr_b16 v[74:75], v14 offset:61440
    ds_read_b64_tr_b16 v[76:77], v15 offset:57344
    ds_read_b64_tr_b16 v[78:79], v15 offset:61440
    s_waitcnt lgkmcnt(4)
    v_mfma_f32_16x16x32_bf16 v[24:27], v[64:67], v[56:59], v[24:27]
    v_mfma_f32_16x16x32_bf16 v[28:31], v[68:71], v[56:59], v[28:31]
    s_waitcnt lgkmcnt(0)
    v_mfma_f32_16x16x32_bf16 v[24:27], v[72:75], v[60:63], v[24:27]
    v_mfma_f32_16x16x32_bf16 v[28:31], v[76:79], v[60:63], v[28:31]
    v_lshl_add_u32 v14, v4, 3, v6
    v_lshl_add_u32 v14, v14, 8, v13
    v_add_u32 v14, 65536, v14
    v_xor_b32 v15, 32, v14
    s_nop 3
    v_cndmask_b32 v24, v28, v24, s[46:47]
    v_cndmask_b32 v25, v29, v25, s[46:47]
    v_cndmask_b32 v26, v30, v26, s[46:47]
    v_cndmask_b32 v27, v31, v27, s[46:47]
    v_cvt_pk_bf16_f32 v24, v24, v25
    v_cvt_pk_bf16_f32 v25, v26, v27
    v_min_u32 v24, -2, v24
    v_min_u32 v25, -2, v25
    ds_bpermute_b32 v24, v17, v24
    ds_bpermute_b32 v25, v17, v25
    s_waitcnt lgkmcnt(0)
    buffer_store_dwordx2 v[24:25], v16, s[36:39], s56 offen sc1
    s_mov_b64 exec, 1
    ds_add_rtn_u32 v3, v10, v11 offset:32
    s_mov_b64 exec, -1
    s_add_u32 s49, s55, 131072
    s_waitcnt lgkmcnt(0)
    v_readfirstlane_b32 s7, v3
    s_cmp_eq_u32 s7, 3
    s_cbranch_scc0 NF_43
    s_mov_b64 exec, 255
    buffer_store_byte v21, v23, s[36:39], s49 offen sc1
    s_mov_b64 exec, -1
NF_43:
    s_branch L_x0
L_npv:
    s_cmp_eq_u32 s23, 7
    s_cbranch_scc0 L_noml
W_44:
    ds_read_b32 v3, v10 offset:28
    s_waitcnt lgkmcnt(0)
    v_readfirstlane_b32 s7, v3
    s_cmp_ge_u32 s7, 8
    s_cbranch_scc1 WE_45
    s_sub_u32 s33, s33, 1
    s_cbranch_scc0 W_44
    s_mov_b32 s33, 0
WE_45:
    ds_read_b128 v[64:67], v16 offset:256
    ds_read_b128 v[68:71], v16 offset:272
    v_lshlrev_b32 v3, 9, v8
    s_lshl_b32 s57, s3, 12
    s_lshl_b32 s7, s4, 4
    s_add_u32 s57, s57, s7
    s_add_u32 s57, s57, 3145728
    s_waitcnt lgkmcnt(0)
    v_pk_add_f32 v[64:65], v[64:65], v[68:69]
    v_pk_add_f32 v[66:67], v[66:67], v[70:71]
    v_pk_add_f32 v[64:65], v[64:65], v[66:67]
    v_add_f32 v65, v64, v65
    v_mov_b32 v64, v72
    v_lshlrev_b32 v66, 8, v72
    v_mov_b32 v67, v65
    v_perm_b32 v64, v64, v21, s29
    v_perm_b32 v65, v65, v21, s30
    v_perm_b32 v66, v66, v21, s31
    v_perm_b32 v67, v67, v21, s32
    s_mov_b64 exec, 0xff
    buffer_store_dwordx4 v[64:67], v3, s[36:39], s57 offen sc1
    s_mov_b64 exec, -1
L_noml:
    s_and_b32 s54, s23, 3
    s_lshl_b32 s57, s5, 5
    s_add_u32 s57, s57, s4
    s_and_b32 s58, s57, -1
    s_lshl_b32 s58, s58, 9
    s_lshl_b32 s7, s54, 7
    s_add_u32 s58, s58, s7
    s_add_u32 s58, s58, 131072
    s_and_b32 s57, s57, -2
    v_lshrrev_b32 v16, 5, v2
    v_and_b32 v19, 1, v4
    v_lshlrev_b32 v17, 13, v16
    v_lshl_add_u32 v17, v19, 10, v17
    v_lshl_add_u32 v17, v5, 4, v17
    v_lshlrev_b32 v18, 9, v16
    v_lshl_add_u32 v18, v19, 6, v18
    v_lshl_add_u32 v18, v7, 4, v18
    s_lshl_b32 s61, s57, 13
    s_lshl_b32 s7, s54, 11
    s_add_u32 s61, s61, s7
    s_add_u32 s61, s61, 2097152
    s_lshl_b32 s62, s57, 9
    s_lshl_b32 s7, s54, 7
    s_add_u32 s62, s62, s7
    s_add_u32 s62, s62, 3145728
    s_lshl_b32 s7, s54, 1
    v_add_u32 v19, s7, v19
    v_lshl_add_u32 v1, v16, 4, v5
    s_lshr_b32 s7, s68, 1
    v_xor_b32 v1, s7, v1
    v_lshlrev_b32 v3, 1, v19
    v_xor_b32 v1, v1, v3
    v_lshlrev_b32 v1, 4, v1
    v_lshl_add_u32 v1, v19, 9, v1
    v_add_u32 v1, 137216, v1
    s_cmp_ge_u32 s50, 25
    s_cbranch_scc1 PE_46
    s_mov_b32 s51, 25
    s_call_b64 s[52:53], L_waitprog
PE_46:
L_h2:
    s_load_dwordx2 s[8:9], s[20:21], s58 glc
    s_waitcnt lgkmcnt(0)
    s_cmp_eq_u64 s[8:9], s[44:45]
    s_cbranch_scc1 L_h2e
    s_sub_u32 s33, s33, 64
    s_cbranch_scc0 L_h2
    s_mov_b32 s33, 0
L_h2e:
L_og1:
L_og:
    buffer_load_dwordx4 v[80:83], v18, s[36:39], s62 offen sc1
    buffer_load_dwordx4 v[64:67], v17, s[36:39], s61 offen sc1
    buffer_load_dwordx4 v[68:71], v17, s[36:39], s61 offen offset:256 sc1
    buffer_load_dwordx4 v[72:75], v17, s[36:39], s61 offen offset:512 sc1
    buffer_load_dwordx4 v[76:79], v17, s[36:39], s61 offen offset:768 sc1
L_ogw:
    s_waitcnt vmcnt(4)
    v_xor_b32 v3, s25, v80
    v_bitop3_b32 v3, v81, s26, v3 bitop3:0xbe
    v_bitop3_b32 v3, v82, s27, v3 bitop3:0xbe
    v_bitop3_b32 v3, v83, s28, v3 bitop3:0xbe
    v_perm_b32 v80, v80, v82, s30
    s_nop 1
    v_max_f32_dpp v82, v80, v80 quad_perm:[1,0,3,2] row_mask:0xf bank_mask:0xf
    s_nop 1
    v_max_f32_dpp v82, v82, v82 quad_perm:[2,3,0,1] row_mask:0xf bank_mask:0xf
    v_sub_f32 v80, v80, v82
    v_mul_f32 v80, s59, v80
    v_exp_f32 v80, v80
    s_nop 0
    v_mul_f32 v81, v81, v80
    s_nop 1
    v_add_f32_dpp v81, v81, v81 quad_perm:[1,0,3,2] row_mask:0xf bank_mask:0xf
    s_nop 1
    v_add_f32_dpp v81, v81, v81 quad_perm:[2,3,0,1] row_mask:0xf bank_mask:0xf
    v_rcp_f32 v81, v81
    s_nop 0
    v_mul_f32 v80, v80, v81
    v_and_b32 v3, 255, v3
    v_cmp_ne_u32 vcc, 0, v3
    v_mov_b32_dpp v84, v80 quad_perm:[0,0,0,0] row_mask:0xf bank_mask:0xf
    v_mov_b32_dpp v85, v80 quad_perm:[1,1,1,1] row_mask:0xf bank_mask:0xf
    v_mov_b32_dpp v86, v80 quad_perm:[2,2,2,2] row_mask:0xf bank_mask:0xf
    v_mov_b32_dpp v87, v80 quad_perm:[3,3,3,3] row_mask:0xf bank_mask:0xf
    v_cndmask_b32 v3, 0, -1, vcc
    s_waitcnt vmcnt(3)
    v_max3_u32 v3, v3, v64, v65
    v_max3_u32 v3, v3, v66, v67
    v_lshlrev_b32 v80, 16, v64
    v_and_b32 v81, 0xffff0000, v64
    v_pk_mul_f32 v[24:25], v[80:81], v[84:85] op_sel:[0,0] op_sel_hi:[1,0]
    v_lshlrev_b32 v82, 16, v65
    v_and_b32 v83, 0xffff0000, v65
    v_pk_mul_f32 v[26:27], v[82:83], v[84:85] op_sel:[0,0] op_sel_hi:[1,0]
    v_lshlrev_b32 v80, 16, v66
    v_and_b32 v81, 0xffff0000, v66
    v_pk_mul_f32 v[28:29], v[80:81], v[84:85] op_sel:[0,0] op_sel_hi:[1,0]
    v_lshlrev_b32 v82, 16, v67
    v_and_b32 v83, 0xffff0000, v67
    v_pk_mul_f32 v[30:31], v[82:83], v[84:85] op_sel:[0,0] op_sel_hi:[1,0]
    s_waitcnt vmcnt(2)
    v_max3_u32 v3, v3, v68, v69
    v_max3_u32 v3, v3, v70, v71
    v_lshlrev_b32 v80, 16, v68
    v_and_b32 v81, 0xffff0000, v68
    v_pk_fma_f32 v[24:25], v[80:81], v[84:85], v[24:25] op_sel:[0,1,0] op_sel_hi:[1,1,1]
    v_lshlrev_b32 v82, 16, v69
    v_and_b32 v83, 0xffff0000, v69
    v_pk_fma_f32 v[26:27], v[82:83], v[84:85], v[26:27] op_sel:[0,1,0] op_sel_hi:[1,1,1]
    v_lshlrev_b32 v80, 16, v70
    v_and_b32 v81, 0xffff0000, v70
    v_pk_fma_f32 v[28:29], v[80:81], v[84:85], v[28:29] op_sel:[0,1,0] op_sel_hi:[1,1,1]
    v_lshlrev_b32 v82, 16, v71
    v_and_b32 v83, 0xffff0000, v71
    v_pk_fma_f32 v[30:31], v[82:83], v[84:85], v[30:31] op_sel:[0,1,0] op_sel_hi:[1,1,1]
    s_waitcnt vmcnt(1)
    v_max3_u32 v3, v3, v72, v73
    v_max3_u32 v3, v3, v74, v75
    v_lshlrev_b32 v80, 16, v72
    v_and_b32 v81, 0xffff0000, v72
    v_pk_fma_f32 v[24:25], v[80:81], v[86:87], v[24:25] op_sel:[0,0,0] op_sel_hi:[1,0,1]
    v_lshlrev_b32 v82, 16, v73
    v_and_b32 v83, 0xffff0000, v73
    v_pk_fma_f32 v[26:27], v[82:83], v[86:87], v[26:27] op_sel:[0,0,0] op_sel_hi:[1,0,1]
    v_lshlrev_b32 v80, 16, v74
    v_and_b32 v81, 0xffff0000, v74
    v_pk_fma_f32 v[28:29], v[80:81], v[86:87], v[28:29] op_sel:[0,0,0] op_sel_hi:[1,0,1]
    v_lshlrev_b32 v82, 16, v75
    v_and_b32 v83, 0xffff0000, v75
    v_pk_fma_f32 v[30:31], v[82:83], v[86:87], v[30:31] op_sel:[0,0,0] op_sel_hi:[1,0,1]
    s_waitcnt vmcnt(0)
    v_max3_u32 v3, v3, v76, v77
    v_max3_u32 v3, v3, v78, v79
    v_lshlrev_b32 v80, 16, v76
    v_and_b32 v81, 0xffff0000, v76
    v_pk_fma_f32 v[24:25], v[80:81], v[86:87], v[24:25] op_sel:[0,1,0] op_sel_hi:[1,1,1]
    v_lshlrev_b32 v82, 16, v77
    v_and_b32 v83, 0xffff0000, v77
    v_pk_fma_f32 v[26:27], v[82:83], v[86:87], v[26:27] op_sel:[0,1,0] op_sel_hi:[1,1,1]
    v_lshlrev_b32 v80, 16, v78
    v_and_b32 v81, 0xffff0000, v78
    v_pk_fma_f32 v[28:29], v[80:81], v[86:87], v[28:29] op_sel:[0,1,0] op_sel_hi:[1,1,1]
    v_lshlrev_b32 v82, 16, v79
    v_and_b32 v83, 0xffff0000, v79
    v_pk_fma_f32 v[30:31], v[82:83], v[86:87], v[30:31] op_sel:[0,1,0] op_sel_hi:[1,1,1]
    v_cvt_pk_bf16_f32 v24, v24, v25
    v_cvt_pk_bf16_f32 v25, v26, v27
    v_cvt_pk_bf16_f32 v26, v28, v29
    v_cvt_pk_bf16_f32 v27, v30, v31
    v_cmp_eq_u32 vcc, -1, v3
    s_cbranch_vccz L_ook
    s_sub_u32 s33, s33, 256
    s_cbranch_scc0 L_og
    s_mov_b32 s33, 0
L_ook:
    ds_write_b128 v1, v[24:27]
    s_waitcnt lgkmcnt(0)
    s_mov_b64 exec, 1
    ds_add_u32 v10, v11 offset:252
    s_mov_b64 exec, -1
    s_branch L_fin
L_x0:
    s_mov_b32 s54, 0
    ds_read2_b32 v[98:99], v10 offset0:63 offset1:64
    s_waitcnt lgkmcnt(0)
    v_readfirstlane_b32 s7, v98
    v_readfirstlane_b32 s50, v99
    s_cmp_ge_u32 s7, 4
    s_cbranch_scc1 L_y
    s_cmp_ge_u32 s50, 26
    s_cbranch_scc1 L_xr0
    s_sub_u32 s33, s33, 1
    s_cbranch_scc0 L_x0
    s_mov_b32 s33, 0
    s_branch L_y
L_xr0:
    ds_read_b64_tr_b16 v[32:33], v14 offset:0
    ds_read_b64_tr_b16 v[34:35], v14 offset:1024
    ds_read_b64_tr_b16 v[36:37], v15 offset:0
    ds_read_b64_tr_b16 v[38:39], v15 offset:1024
    ds_read_b64_tr_b16 v[40:41], v14 offset:8192
    ds_read_b64_tr_b16 v[42:43], v14 offset:9216
    ds_read_b64_tr_b16 v[44:45], v15 offset:8192
    ds_read_b64_tr_b16 v[46:47], v15 offset:9216
L_x1:
    s_mov_b32 s54, 1
    ds_read2_b32 v[98:99], v10 offset0:63 offset1:64
    s_waitcnt lgkmcnt(0)
    v_readfirstlane_b32 s7, v98
    v_readfirstlane_b32 s50, v99
    s_cmp_ge_u32 s7, 4
    s_cbranch_scc1 L_y
    s_cmp_ge_u32 s50, 28
    s_cbranch_scc1 L_xr1
    s_sub_u32 s33, s33, 1
    s_cbranch_scc0 L_x1
    s_mov_b32 s33, 0
    s_branch L_y
L_xr1:
    buffer_load_dwordx4 v[20:23], v18, s[36:39], s63 offen sc1
    ds_read_b64_tr_b16 v[48:49], v14 offset:16384
    ds_read_b64_tr_b16 v[50:51], v14 offset:17408
    ds_read_b64_tr_b16 v[52:53], v15 offset:16384
    ds_read_b64_tr_b16 v[54:55], v15 offset:17408
    ds_read_b64_tr_b16 v[56:57], v14 offset:24576
    ds_read_b64_tr_b16 v[58:59], v14 offset:25600
    ds_read_b64_tr_b16 v[60:61], v15 offset:24576
    ds_read_b64_tr_b16 v[62:63], v15 offset:25600
L_x2:
    s_mov_b32 s54, 2
    ds_read2_b32 v[98:99], v10 offset0:63 offset1:64
    s_waitcnt lgkmcnt(0)
    v_readfirstlane_b32 s7, v98
    v_readfirstlane_b32 s50, v99
    s_cmp_ge_u32 s7, 4
    s_cbranch_scc1 L_y
    s_cmp_ge_u32 s50, 30
    s_cbranch_scc1 L_xr2
    s_sub_u32 s33, s33, 1
    s_cbranch_scc0 L_x2
    s_mov_b32 s33, 0
    s_branch L_y
L_xr2:
    ds_read_b64_tr_b16 v[64:65], v14 offset:32768
    ds_read_b64_tr_b16 v[66:67], v14 offset:33792
    ds_read_b64_tr_b16 v[68:69], v15 offset:32768
    ds_read_b64_tr_b16 v[70:71], v15 offset:33792
    ds_read_b64_tr_b16 v[72:73], v14 offset:40960
    ds_read_b64_tr_b16 v[74:75], v14 offset:41984
    ds_read_b64_tr_b16 v[76:77], v15 offset:40960
    ds_read_b64_tr_b16 v[78:79], v15 offset:41984
L_x3:
    s_mov_b32 s54, 3
    ds_read2_b32 v[98:99], v10 offset0:63 offset1:64
    s_waitcnt lgkmcnt(0)
    v_readfirstlane_b32 s7, v98
    v_readfirstlane_b32 s50, v99
    s_cmp_ge_u32 s7, 4
    s_cbranch_scc1 L_y
    s_cmp_ge_u32 s50, 32
    s_cbranch_scc1 L_xr3
    s_sub_u32 s33, s33, 1
    s_cbranch_scc0 L_x3
    s_mov_b32 s33, 0
    s_branch L_y
L_xr3:
    ds_read_b64_tr_b16 v[80:81], v14 offset:49152
    ds_read_b64_tr_b16 v[82:83], v14 offset:50176
    ds_read_b64_tr_b16 v[84:85], v15 offset:49152
    ds_read_b64_tr_b16 v[86:87], v15 offset:50176
    ds_read_b64_tr_b16 v[88:89], v14 offset:57344
    ds_read_b64_tr_b16 v[90:91], v14 offset:58368
    ds_read_b64_tr_b16 v[92:93], v15 offset:57344
    ds_read_b64_tr_b16 v[94:95], v15 offset:58368
L_x4:
    s_mov_b32 s54, 4
    ds_read2_b32 v[98:99], v10 offset0:63 offset1:64
    s_waitcnt lgkmcnt(0)
    v_readfirstlane_b32 s7, v98
    v_readfirstlane_b32 s50, v99
    s_cmp_ge_u32 s7, 4
    s_cbranch_scc1 L_y
    s_sub_u32 s33, s33, 1
    s_cbranch_scc0 L_x4
    s_mov_b32 s33, 0
    s_branch L_y
L_y:
    ds_read_b128 v[100:103], v132 offset:0
    ds_read_b128 v[104:107], v133 offset:0
    ds_read_b128 v[108:111], v134 offset:0
    ds_read_b128 v[112:115], v135 offset:0
    ds_read_b128 v[116:119], v132 offset:256
    ds_read_b128 v[120:123], v133 offset:256
    ds_read_b128 v[124:127], v134 offset:256
    ds_read_b128 v[128:131], v135 offset:256
    s_add_u32 s49, s55, 327680
    v_mov_b32 v98, s24
    v_xor_b32 v19, 0x80808080, v98
    s_cmp_eq_u32 s54, 4
    s_cbranch_scc0 L_yslow
    s_waitcnt lgkmcnt(7)
    v_mfma_f32_16x16x32_bf16 v[24:27], v[32:35], v[100:103], 0
    v_mfma_f32_16x16x32_bf16 v[28:31], v[36:39], v[100:103], 0
    s_waitcnt lgkmcnt(6)
    v_mfma_f32_16x16x32_bf16 v[24:27], v[40:43], v[104:107], v[24:27]
    v_mfma_f32_16x16x32_bf16 v[28:31], v[44:47], v[104:107], v[28:31]
    s_waitcnt lgkmcnt(5)
    v_mfma_f32_16x16x32_bf16 v[24:27], v[48:51], v[108:111], v[24:27]
    v_mfma_f32_16x16x32_bf16 v[28:31], v[52:55], v[108:111], v[28:31]
    s_waitcnt lgkmcnt(4)
    v_mfma_f32_16x16x32_bf16 v[24:27], v[56:59], v[112:115], v[24:27]
    v_mfma_f32_16x16x32_bf16 v[28:31], v[60:63], v[112:115], v[28:31]
    s_waitcnt lgkmcnt(3)
    v_mfma_f32_16x16x32_bf16 v[24:27], v[64:67], v[116:119], v[24:27]
    v_mfma_f32_16x16x32_bf16 v[28:31], v[68:71], v[116:119], v[28:31]
    s_waitcnt lgkmcnt(2)
    v_mfma_f32_16x16x32_bf16 v[24:27], v[72:75], v[120:123], v[24:27]
    v_mfma_f32_16x16x32_bf16 v[28:31], v[76:79], v[120:123], v[28:31]
    s_waitcnt lgkmcnt(1)
    v_mfma_f32_16x16x32_bf16 v[24:27], v[80:83], v[124:127], v[24:27]
    v_mfma_f32_16x16x32_bf16 v[28:31], v[84:87], v[124:127], v[28:31]
    s_waitcnt lgkmcnt(0)
    v_mfma_f32_16x16x32_bf16 v[24:27], v[88:91], v[128:131], v[24:27]
    v_mfma_f32_16x16x32_bf16 v[28:31], v[92:95], v[128:131], v[28:31]
L_ydone:
    s_waitcnt vmcnt(0)
    v_xor_b32 v3, s25, v20
    v_bitop3_b32 v3, v21, s26, v3 bitop3:0xbe
    v_bitop3_b32 v3, v22, s27, v3 bitop3:0xbe
    v_bitop3_b32 v3, v23, s28, v3 bitop3:0xbe
    v_and_b32 v3, 255, v3
    v_cmp_ne_u32 vcc, 0, v3
    s_cbranch_vccnz L_qd
L_qdok:
    v_cndmask_b32 v24, v28, v24, s[46:47]
    v_cndmask_b32 v25, v29, v25, s[46:47]
    v_cndmask_b32 v26, v30, v26, s[46:47]
    v_cndmask_b32 v27, v31, v27, s[46:47]
    v_perm_b32 v24, v24, v19, s29
    v_perm_b32 v25, v25, v19, s30
    v_perm_b32 v26, v26, v19, s31
    v_perm_b32 v27, v27, v19, s32
    s_cmp_eq_u32 s48, 1
    s_cbranch_scc0 M_47
    buffer_store_dwordx4 v[24:27], v97, s[36:39], s60 offen
    s_branch ME_48
M_47:
    buffer_store_dwordx4 v[24:27], v97, s[36:39], s60 offen sc1
ME_48:
    s_mov_b64 exec, 1
    ds_add_u32 v10, v11 offset:40
    s_mov_b64 exec, -1
    s_cmp_eq_u32 s48, 1
    s_cbranch_scc1 L_fin
    s_barrier
    s_cmp_eq_u32 s23, 0
    s_cbranch_scc0 L_fin
    v_mov_b32 v21, s24
    v_lshlrev_b32 v23, 9, v2
    s_mov_b64 exec, 255
    buffer_store_byte v21, v23, s[36:39], s49 offen sc1
    s_mov_b64 exec, -1
L_fin:
L_end:
    s_endpgm
L_qd:
    buffer_load_dwordx4 v[20:23], v18, s[36:39], s63 offen sc1
    s_waitcnt vmcnt(0)
    v_xor_b32 v3, s25, v20
    v_bitop3_b32 v3, v21, s26, v3 bitop3:0xbe
    v_bitop3_b32 v3, v22, s27, v3 bitop3:0xbe
    v_bitop3_b32 v3, v23, s28, v3 bitop3:0xbe
    v_and_b32 v3, 255, v3
    v_cmp_ne_u32 vcc, 0, v3
    s_cbranch_vccz L_qd2
    s_sub_u32 s33, s33, 256
    s_cbranch_scc0 L_qd
    s_mov_b32 s33, 0
L_qd2:
    s_branch L_qdok
L_yslow:
L_yp:
    s_cmp_gt_u32 s54, 0
    s_cbranch_scc1 L_ys0
    s_cmp_ge_u32 s50, 26
    s_cbranch_scc1 PE_49
    s_mov_b32 s51, 26
    s_call_b64 s[52:53], L_waitprog
PE_49:
    ds_read_b64_tr_b16 v[32:33], v14 offset:0
    ds_read_b64_tr_b16 v[34:35], v14 offset:1024
    ds_read_b64_tr_b16 v[36:37], v15 offset:0
    ds_read_b64_tr_b16 v[38:39], v15 offset:1024
    ds_read_b64_tr_b16 v[40:41], v14 offset:8192
    ds_read_b64_tr_b16 v[42:43], v14 offset:9216
    ds_read_b64_tr_b16 v[44:45], v15 offset:8192
    ds_read_b64_tr_b16 v[46:47], v15 offset:9216
L_ys0:
    s_waitcnt lgkmcnt(0)
    v_mfma_f32_16x16x32_bf16 v[24:27], v[32:35], v[100:103], 0
    v_mfma_f32_16x16x32_bf16 v[28:31], v[36:39], v[100:103], 0
    v_mfma_f32_16x16x32_bf16 v[24:27], v[40:43], v[104:107], v[24:27]
    v_mfma_f32_16x16x32_bf16 v[28:31], v[44:47], v[104:107], v[28:31]
    s_cmp_gt_u32 s54, 1
    s_cbranch_scc1 L_ys1
    s_cmp_ge_u32 s50, 28
    s_cbranch_scc1 PE_50
    s_mov_b32 s51, 28
    s_call_b64 s[52:53], L_waitprog
PE_50:
    buffer_load_dwordx4 v[20:23], v18, s[36:39], s63 offen sc1
    ds_read_b64_tr_b16 v[48:49], v14 offset:16384
    ds_read_b64_tr_b16 v[50:51], v14 offset:17408
    ds_read_b64_tr_b16 v[52:53], v15 offset:16384
    ds_read_b64_tr_b16 v[54:55], v15 offset:17408
    ds_read_b64_tr_b16 v[56:57], v14 offset:24576
    ds_read_b64_tr_b16 v[58:59], v14 offset:25600
    ds_read_b64_tr_b16 v[60:61], v15 offset:24576
    ds_read_b64_tr_b16 v[62:63], v15 offset:25600
L_ys1:
    s_waitcnt lgkmcnt(0)
    v_mfma_f32_16x16x32_bf16 v[24:27], v[48:51], v[108:111], v[24:27]
    v_mfma_f32_16x16x32_bf16 v[28:31], v[52:55], v[108:111], v[28:31]
    v_mfma_f32_16x16x32_bf16 v[24:27], v[56:59], v[112:115], v[24:27]
    v_mfma_f32_16x16x32_bf16 v[28:31], v[60:63], v[112:115], v[28:31]
    s_cmp_gt_u32 s54, 2
    s_cbranch_scc1 L_ys2
    s_cmp_ge_u32 s50, 30
    s_cbranch_scc1 PE_51
    s_mov_b32 s51, 30
    s_call_b64 s[52:53], L_waitprog
PE_51:
    ds_read_b64_tr_b16 v[64:65], v14 offset:32768
    ds_read_b64_tr_b16 v[66:67], v14 offset:33792
    ds_read_b64_tr_b16 v[68:69], v15 offset:32768
    ds_read_b64_tr_b16 v[70:71], v15 offset:33792
    ds_read_b64_tr_b16 v[72:73], v14 offset:40960
    ds_read_b64_tr_b16 v[74:75], v14 offset:41984
    ds_read_b64_tr_b16 v[76:77], v15 offset:40960
    ds_read_b64_tr_b16 v[78:79], v15 offset:41984
L_ys2:
    s_waitcnt lgkmcnt(0)
    v_mfma_f32_16x16x32_bf16 v[24:27], v[64:67], v[116:119], v[24:27]
    v_mfma_f32_16x16x32_bf16 v[28:31], v[68:71], v[116:119], v[28:31]
    v_mfma_f32_16x16x32_bf16 v[24:27], v[72:75], v[120:123], v[24:27]
    v_mfma_f32_16x16x32_bf16 v[28:31], v[76:79], v[120:123], v[28:31]
    s_cmp_gt_u32 s54, 3
    s_cbranch_scc1 L_ys3
    s_cmp_ge_u32 s50, 31
    s_cbranch_scc1 PE_52
    s_mov_b32 s51, 31
    s_call_b64 s[52:53], L_waitprog
PE_52:
    ds_read_b64_tr_b16 v[80:81], v14 offset:49152
    ds_read_b64_tr_b16 v[82:83], v14 offset:50176
    ds_read_b64_tr_b16 v[84:85], v15 offset:49152
    ds_read_b64_tr_b16 v[86:87], v15 offset:50176
    s_waitcnt lgkmcnt(0)
    v_mfma_f32_16x16x32_bf16 v[24:27], v[80:83], v[124:127], v[24:27]
    v_mfma_f32_16x16x32_bf16 v[28:31], v[84:87], v[124:127], v[28:31]
    s_cmp_ge_u32 s50, 32
    s_cbranch_scc1 PE_53
    s_mov_b32 s51, 32
    s_call_b64 s[52:53], L_waitprog
PE_53:
    ds_read_b64_tr_b16 v[88:89], v14 offset:57344
    ds_read_b64_tr_b16 v[90:91], v14 offset:58368
    ds_read_b64_tr_b16 v[92:93], v15 offset:57344
    ds_read_b64_tr_b16 v[94:95], v15 offset:58368
    s_waitcnt lgkmcnt(0)
    v_mfma_f32_16x16x32_bf16 v[24:27], v[88:91], v[128:131], v[24:27]
    v_mfma_f32_16x16x32_bf16 v[28:31], v[92:95], v[128:131], v[28:31]
    s_branch L_ydone
L_ys3:
    s_waitcnt lgkmcnt(0)
    v_mfma_f32_16x16x32_bf16 v[24:27], v[80:83], v[124:127], v[24:27]
    v_mfma_f32_16x16x32_bf16 v[28:31], v[84:87], v[124:127], v[28:31]
    v_mfma_f32_16x16x32_bf16 v[24:27], v[88:91], v[128:131], v[24:27]
    v_mfma_f32_16x16x32_bf16 v[28:31], v[92:95], v[128:131], v[28:31]
    s_branch L_ydone

.section .rodata,"a"
.p2align 6
.amdhsa_kernel concat_heads__sliding_block_cached__sliding_block_cached__decode_kernel
  .amdhsa_next_free_vgpr 136
  .amdhsa_next_free_sgpr 102
  .amdhsa_accum_offset 136
  .amdhsa_group_segment_fixed_size 0
  .amdhsa_kernarg_size 104
  .amdhsa_user_sgpr_count 2
  .amdhsa_user_sgpr_kernarg_segment_ptr 1
  .amdhsa_system_sgpr_workgroup_id_x 1
.end_amdhsa_kernel
```
